```python
import torch

def _softmax(x, axis=-1):
    return torch.softmax(x, dim=axis)
def _gelu(x):
    return torch.nn.functional.gelu(x, approximate="tanh")
def _silu(x):
    return torch.nn.functional.silu(x)
def _sigmoid(x):
    return torch.sigmoid(x)
def _layernorm(x, axis=-1, eps=1e-5):
    m = x.mean(dim=axis, keepdim=True)
    v = x.var(dim=axis, keepdim=True, unbiased=False)
    return (x - m) / torch.sqrt(v + eps)
def _scatter_add(tgt, idx, src, axis=0):
    return tgt.clone().index_add_(axis, idx, src)
def _segment_sum(src, seg, n):
    out = torch.zeros((n,) + src.shape[1:], dtype=src.dtype)
    return out.index_add_(0, seg, src)
def _pad(x, pw):
    flat = tuple(v for pair in reversed(pw) for v in pair)
    return torch.nn.functional.pad(x, flat)

kernel_name = 'standalone__gqa_block_cached__decode'

def setup_inputs():

    _w = (lambda a: (lambda t: t.to(torch.bfloat16) if t.is_floating_point() else t)(torch.as_tensor(a)))
    B, Sq, D = 8, 1, 512
    Hq, Hkv, Sk, Dh = 32, 8, 4096, 128
    assert Hq % Hkv == 0, (Hq, Hkv)
    return {
        "x": _w((lambda *s: torch.randn(*s, dtype=torch.bfloat16) * 0.8)(B, Sq, D)),
        "k_cache": _w((lambda *s: torch.randn(*s, dtype=torch.bfloat16) * 0.8)(B, Hkv, Sk, Dh)),
        "v_cache": _w((lambda *s: torch.randn(*s, dtype=torch.bfloat16) * 0.05)(B, Hkv, Sk, Dh)),
        "wq": _w((lambda *s: torch.randn(*s, dtype=torch.bfloat16) * 0.8)(D, Hq * Dh) * (D ** -0.5)),
        "wo": _w((lambda *s: torch.randn(*s, dtype=torch.bfloat16) * 0.05)(Hq * Dh, D) * ((Hq * Dh) ** -0.5)),
    }

def reference(x, k_cache, v_cache, wq, wo):
    B, Sq, D = x.shape
    Hq, Dh = 32, 128
    Hkv = k_cache.shape[1]
    rep = Hq // Hkv
    q = (lambda x, *d: x.permute(*d))((x @ wq).reshape(B, Sq, Hq, Dh), 0, 2, 1, 3)
    k = (lambda x, n, axis: torch.repeat_interleave(x, n, dim=axis))(k_cache, rep, axis=1)
    v = (lambda x, n, axis: torch.repeat_interleave(x, n, dim=axis))(v_cache, rep, axis=1)
    scores = torch.einsum("bhqd,bhkd->bhqk", q, k) * (Dh ** -0.5)
    p = _softmax(scores, axis=-1)
    o = torch.einsum("bhqk,bhkd->bhqd", p, v)
    return (lambda x, *d: x.permute(*d))(o, 0, 2, 1, 3).reshape(B, Sq, Hq * Dh) @ wo
```

```asm
; @launch grid=(256,1,1) block=(512,1,1) lds=69120
.amdgcn_target "amdgcn-amd-amdhsa--gfx950"
.text
.globl standalone__gqa_block_cached__decode_kernel
.p2align 8
.type standalone__gqa_block_cached__decode_kernel,@function
standalone__gqa_block_cached__decode_kernel:
  s_cmp_ge_u32 s2, 256
  s_cbranch_scc1 L_end
  s_load_dwordx16 s[16:31], s[0:1], 0
  v_lshrrev_b32 v1, 6, v0
  s_nop 0
  v_readfirstlane_b32 s3, v1
  v_and_b32 v1, 63, v0
  v_lshrrev_b32 v2, 4, v1
  v_and_b32 v3, 15, v1
  s_and_b32 s4, s2, 7
  s_lshr_b32 s5, s2, 3
  s_lshr_b32 s6, s5, 2
  s_and_b32 s7, s5, 3
  s_lshr_b32 s8, s5, 3
  s_and_b32 s9, s5, 7
  s_lshl_b32 s10, s4, 2
  s_add_u32 s10, s10, s8
  s_mov_b32 s65, 4096
  s_mov_b32 s66, 8192
  s_mov_b32 s67, 12288
  s_mov_b32 s68, 16384
  s_mov_b32 s69, 20480
  s_mov_b32 s70, 24576
  s_mov_b32 s71, 28672
  s_mov_b32 s72, 32768
  s_lshl_b32 s11, s8, 7
  s_lshl_b32 s12, s3, 4
  s_add_u32 s11, s11, s12
  s_lshl_b32 s12, s11, 13
  s_lshl_b32 s13, s4, 10
  s_add_u32 s12, s12, s13
  s_lshl_b32 s13, s9, 7
  s_add_u32 s12, s12, s13
  v_lshrrev_b32 v8, 3, v3
  v_lshl_add_u32 v8, v2, 2, v8
  v_lshlrev_b32 v8, 13, v8
  v_and_b32 v9, 7, v3
  v_lshl_add_u32 v8, v9, 4, v8
  v_add_u32 v8, s12, v8
  v_lshrrev_b32 v9, 2, v3
  v_lshlrev_b32 v9, 10, v9
  v_lshl_add_u32 v9, v2, 3, v9
  s_lshl_b32 s13, s11, 1
  v_add_u32 v9, s13, v9
  s_lshl_b32 s13, s6, 5
  s_lshl_b32 s14, s4, 2
  s_add_u32 s13, s13, s14
  s_lshl_b32 s13, s13, 18
  s_lshl_b32 s14, s7, 15
  s_add_u32 s13, s13, s14
  s_lshl_b32 s14, s3, 12
  s_add_u32 s13, s13, s14
  v_and_b32 v4, 3, v3
  v_bfe_u32 v5, v3, 2, 1
  v_lshl_add_u32 v4, v4, 2, v5
  v_lshlrev_b32 v4, 8, v4
  v_lshl_add_u32 v4, v2, 4, v4
  v_lshrrev_b32 v5, 3, v3
  v_lshl_add_u32 v4, v5, 6, v4
  v_add_u32 v4, s13, v4
  v_lshlrev_b32 v5, 4, v1
  v_add_u32 v5, s13, v5
  s_waitcnt lgkmcnt(0)
  s_mov_b32 s44, s22
  s_and_b32 s45, s23, 0xffff
  s_mov_b32 s46, 4194304
  s_mov_b32 s47, 0x20000
  s_mov_b32 s32, s16
  s_and_b32 s33, s17, 0xffff
  s_mov_b32 s34, 8192
  s_mov_b32 s35, 0x20000
  buffer_load_dwordx4 v[64:67], v8, s[44:47], 0 offen nt
  buffer_load_dwordx4 v[68:71], v8, s[44:47], s68 offen nt
  buffer_load_dwordx2 v[72:73], v9, s[32:35], 0 offen
  buffer_load_dwordx2 v[74:75], v9, s[32:35], s65 offen
  s_mov_b32 s36, s18
  s_and_b32 s37, s19, 0xffff
  s_mov_b32 s38, 67108864
  s_mov_b32 s39, 0x20000
  s_add_u32 s14, s30, 3149824
  s_addc_u32 s15, s31, 0
  s_load_dwordx2 s[74:75], s[14:15], 0
  s_mov_b32 s48, s24
  s_and_b32 s49, s25, 0xffff
  s_mov_b32 s50, 4194304
  s_mov_b32 s51, 0x20000
  s_mov_b32 s40, s20
  s_and_b32 s41, s21, 0xffff
  s_mov_b32 s42, 67108864
  s_mov_b32 s43, 0x20000
  s_mov_b32 s52, s26
  s_and_b32 s53, s27, 0xffff
  s_mov_b32 s54, 8192
  s_mov_b32 s55, 0x20000
  s_mov_b32 s60, s30
  s_and_b32 s61, s31, 0xffff
  s_mov_b32 s62, 268435456
  s_mov_b32 s63, 0x20000
  s_mul_i32 s13, s6, 3
  s_add_u32 s14, s13, 0
  s_and_b32 s14, s14, 7
  s_lshl_b32 s16, s14, 17
  s_add_u32 s14, s13, 1
  s_and_b32 s14, s14, 7
  s_lshl_b32 s17, s14, 17
  s_add_u32 s14, s13, 2
  s_and_b32 s14, s14, 7
  s_lshl_b32 s18, s14, 17
  s_add_u32 s14, s13, 3
  s_and_b32 s14, s14, 7
  s_lshl_b32 s19, s14, 17
  s_add_u32 s14, s13, 4
  s_and_b32 s14, s14, 7
  s_lshl_b32 s20, s14, 17
  s_add_u32 s14, s13, 5
  s_and_b32 s14, s14, 7
  s_lshl_b32 s21, s14, 17
  s_add_u32 s14, s13, 6
  s_and_b32 s14, s14, 7
  s_lshl_b32 s22, s14, 17
  s_add_u32 s14, s13, 7
  s_and_b32 s14, s14, 7
  s_lshl_b32 s23, s14, 17
  buffer_load_dwordx4 v[128:131], v4, s[36:39], s16 offen offset:0 nt
  buffer_load_dwordx4 v[132:135], v4, s[36:39], s16 offen offset:128 nt
  buffer_load_dwordx4 v[136:139], v4, s[36:39], s16 offen offset:512 nt
  v_and_b32 v14, 1, v1
  v_lshlrev_b32 v14, 4, v14
  v_mov_b32 v15, 0xffff
  v_lshlrev_b32 v15, v14, v15
  v_and_b32 v14, 3, v1
  v_cmp_gt_u32 vcc, 2, v14
  s_nop 1
  v_cndmask_b32 v6, 0, v15, vcc
  v_xor_b32 v7, v15, v6
  s_and_b32 s15, s3, 3
  s_lshl_b32 s13, s10, 7
  s_lshl_b32 s14, s15, 5
  s_add_u32 s13, s13, s14
  s_lshl_b32 s13, s13, 10
  s_lshl_b32 s14, s9, 7
  s_add_u32 s13, s13, s14
  v_lshrrev_b32 v10, 3, v1
  v_and_b32 v11, 7, v1
  v_lshlrev_b32 v12, 10, v10
  v_lshl_add_u32 v12, v11, 4, v12
  v_add_u32 v12, s13, v12
  s_mul_i32 s13, s15, 4128
  s_add_u32 s13, s13, 32768
  v_lshlrev_b32 v13, 4, v1
  v_add_u32 v13, s13, v13
  v_mov_b32 v14, 0x0c0c0c0c
  s_mov_b32 s13, 0x01000100
  s_mov_b32 s14, 0x03020302
  v_bfi_b32 v84, v6, s13, v14
  v_bfi_b32 v85, v7, s13, v14
  v_bfi_b32 v86, v6, s14, v14
  v_bfi_b32 v87, v7, s14, v14
  s_mov_b32 vcc_lo, 0
  s_mov_b32 vcc_hi, -1
  s_lshl_b32 s13, s3, 12
  v_lshlrev_b32 v14, 4, v1
  v_add_u32 v14, s13, v14
  s_waitcnt vmcnt(3)
  v_perm_b32 v88, v72, v72, v84
  v_perm_b32 v89, v72, v72, v85
  s_nop 1
  v_mfma_f32_16x16x16_bf16 v[96:99], v[64:65], v[88:89], 0
  v_mfma_f32_16x16x16_bf16 v[100:103], v[66:67], v[88:89], 0
  v_perm_b32 v90, v72, v72, v86
  v_perm_b32 v91, v72, v72, v87
  s_nop 1
  v_mfma_f32_16x16x16_bf16 v[104:107], v[64:65], v[90:91], 0
  v_mfma_f32_16x16x16_bf16 v[108:111], v[66:67], v[90:91], 0
  v_perm_b32 v92, v74, v74, v84
  v_perm_b32 v93, v74, v74, v85
  s_nop 1
  v_mfma_f32_16x16x16_bf16 v[112:115], v[64:65], v[92:93], 0
  v_mfma_f32_16x16x16_bf16 v[116:119], v[66:67], v[92:93], 0
  v_perm_b32 v94, v74, v74, v86
  v_perm_b32 v95, v74, v74, v87
  s_nop 1
  v_mfma_f32_16x16x16_bf16 v[120:123], v[64:65], v[94:95], 0
  v_mfma_f32_16x16x16_bf16 v[124:127], v[66:67], v[94:95], 0
  v_perm_b32 v88, v73, v73, v84
  v_perm_b32 v89, v73, v73, v85
  s_nop 1
  v_mfma_f32_16x16x16_bf16 v[96:99], v[68:69], v[88:89], v[96:99]
  v_mfma_f32_16x16x16_bf16 v[100:103], v[70:71], v[88:89], v[100:103]
  v_perm_b32 v90, v73, v73, v86
  v_perm_b32 v91, v73, v73, v87
  s_nop 1
  v_mfma_f32_16x16x16_bf16 v[104:107], v[68:69], v[90:91], v[104:107]
  v_mfma_f32_16x16x16_bf16 v[108:111], v[70:71], v[90:91], v[108:111]
  v_perm_b32 v92, v75, v75, v84
  v_perm_b32 v93, v75, v75, v85
  s_nop 1
  v_mfma_f32_16x16x16_bf16 v[112:115], v[68:69], v[92:93], v[112:115]
  v_mfma_f32_16x16x16_bf16 v[116:119], v[70:71], v[92:93], v[116:119]
  v_perm_b32 v94, v75, v75, v86
  v_perm_b32 v95, v75, v75, v87
  s_nop 1
  v_mfma_f32_16x16x16_bf16 v[120:123], v[68:69], v[94:95], v[120:123]
  v_mfma_f32_16x16x16_bf16 v[124:127], v[70:71], v[94:95], v[124:127]
  s_cmp_lg_u32 s3, 0
  s_cbranch_scc1 L_merge
  v_lshrrev_b32 v50, 5, v1
  v_lshlrev_b32 v48, 14, v50
  v_bfe_u32 v50, v1, 3, 2
  v_lshl_add_u32 v48, v50, 10, v48
  v_and_b32 v50, 7, v1
  v_lshl_add_u32 v48, v50, 4, v48
  s_lshl_b32 s13, s4, 16
  s_lshl_b32 s14, s7, 12
  s_add_u32 s13, s13, s14
  s_lshl_b32 s14, s6, 7
  s_add_u32 s13, s13, s14
  s_add_u32 s13, s13, 1048576
  v_add_u32 v48, s13, v48
  v_lshlrev_b32 v49, 8, v3
  s_lshl_b32 s13, s4, 12
  s_lshl_b32 s14, s6, 5
  s_add_u32 s13, s13, s14
  s_lshl_b32 s14, s7, 3
  s_add_u32 s13, s13, s14
  s_add_u32 s13, s13, 1572864
  v_add_u32 v49, s13, v49
  v_mov_b32 v52, -1
  v_mov_b32 v53, -1
  v_mov_b32 v54, -1
  v_mov_b32 v55, -1
  v_add_u32 v50, 4194304, v48
  v_add_u32 v51, 4194304, v49
  buffer_store_dwordx4 v[52:55], v48, s[60:63], 0 offen sc1
  buffer_store_dwordx4 v[52:55], v48, s[60:63], s72 offen sc1
  buffer_store_dwordx4 v[52:55], v50, s[60:63], 0 offen sc1
  buffer_store_dwordx4 v[52:55], v50, s[60:63], s72 offen sc1
  s_mov_b32 exec_lo, 0xffff
  s_mov_b32 exec_hi, 0
  buffer_store_dwordx2 v[52:53], v49, s[60:63], 0 offen sc1
  buffer_store_dwordx2 v[52:53], v51, s[60:63], 0 offen sc1
  s_mov_b64 exec, -1
  buffer_load_dwordx4 v[140:143], v4, s[36:39], s16 offen offset:640 nt
  buffer_load_dwordx4 v[144:147], v4, s[36:39], s17 offen offset:0 nt
  buffer_load_dwordx4 v[148:151], v4, s[36:39], s17 offen offset:128 nt
  buffer_load_dwordx4 v[152:155], v4, s[36:39], s17 offen offset:512 nt
  buffer_load_dwordx4 v[156:159], v4, s[36:39], s17 offen offset:640 nt
  buffer_load_dwordx4 v[160:163], v4, s[36:39], s18 offen offset:0 nt
  buffer_load_dwordx4 v[164:167], v4, s[36:39], s18 offen offset:128 nt
  buffer_load_dwordx4 v[168:171], v4, s[36:39], s18 offen offset:512 nt
  buffer_load_dwordx4 v[172:175], v4, s[36:39], s18 offen offset:640 nt
  buffer_load_dwordx4 v[176:179], v4, s[36:39], s19 offen offset:0 nt
  buffer_load_dwordx4 v[180:183], v4, s[36:39], s19 offen offset:128 nt
  buffer_load_dwordx4 v[184:187], v4, s[36:39], s19 offen offset:512 nt
  buffer_load_dwordx4 v[188:191], v4, s[36:39], s19 offen offset:640 nt
L_merge:
  s_nop 7
  s_nop 3
  v_cndmask_b32 v96, v96, v104, vcc
  v_cndmask_b32 v97, v97, v105, vcc
  v_cndmask_b32 v98, v98, v106, vcc
  v_cndmask_b32 v99, v99, v107, vcc
  ds_write_b128 v14, v[96:99] offset:0
  v_cndmask_b32 v100, v100, v108, vcc
  v_cndmask_b32 v101, v101, v109, vcc
  v_cndmask_b32 v102, v102, v110, vcc
  v_cndmask_b32 v103, v103, v111, vcc
  ds_write_b128 v14, v[100:103] offset:1024
  v_cndmask_b32 v112, v112, v120, vcc
  v_cndmask_b32 v113, v113, v121, vcc
  v_cndmask_b32 v114, v114, v122, vcc
  v_cndmask_b32 v115, v115, v123, vcc
  ds_write_b128 v14, v[112:115] offset:2048
  v_cndmask_b32 v116, v116, v124, vcc
  v_cndmask_b32 v117, v117, v125, vcc
  v_cndmask_b32 v118, v118, v126, vcc
  v_cndmask_b32 v119, v119, v127, vcc
  ds_write_b128 v14, v[116:119] offset:3072
  s_waitcnt lgkmcnt(0)
  s_barrier
  s_mov_b32 s12, 4194304
  s_add_u32 s74, s74, 1
  s_add_u32 s75, s75, 0x9E3779B9
  s_cmp_lg_u32 s3, 0
  s_cbranch_scc1 L_others
  v_lshlrev_b32 v14, 4, v1
  ds_read_b128 v[64:67], v14 offset:0
  ds_read_b128 v[68:71], v14 offset:4096
  ds_read_b128 v[72:75], v14 offset:8192
  ds_read_b128 v[76:79], v14 offset:12288
  ds_read_b128 v[80:83], v14 offset:16384
  ds_read_b128 v[84:87], v14 offset:20480
  ds_read_b128 v[88:91], v14 offset:24576
  ds_read_b128 v[92:95], v14 offset:28672
  ds_read_b128 v[96:99], v14 offset:1024
  ds_read_b128 v[100:103], v14 offset:5120
  ds_read_b128 v[104:107], v14 offset:9216
  ds_read_b128 v[108:111], v14 offset:13312
  ds_read_b128 v[112:115], v14 offset:17408
  ds_read_b128 v[116:119], v14 offset:21504
  ds_read_b128 v[120:123], v14 offset:25600
  ds_read_b128 v[124:127], v14 offset:29696
  s_lshl_b32 s13, s4, 17
  s_lshl_b32 s14, s5, 9
  s_add_u32 s13, s13, s14
  v_bfe_u32 v10, v1, 2, 2
  v_lshlrev_b32 v10, 14, v10
  v_lshl_add_u32 v10, v2, 6, v10
  v_and_b32 v15, 3, v1
  v_lshl_add_u32 v10, v15, 4, v10
  v_add_u32 v56, s13, v10
  v_add_u32 v57, 0x10000, v56
  s_waitcnt lgkmcnt(0)
  v_add_f32 v32, v64, v68
  v_add_f32 v33, v65, v69
  v_add_f32 v34, v66, v70
  v_add_f32 v35, v67, v71
  v_add_f32 v32, v32, v72
  v_add_f32 v33, v33, v73
  v_add_f32 v34, v34, v74
  v_add_f32 v35, v35, v75
  v_add_f32 v32, v32, v76
  v_add_f32 v33, v33, v77
  v_add_f32 v34, v34, v78
  v_add_f32 v35, v35, v79
  v_add_f32 v32, v32, v80
  v_add_f32 v33, v33, v81
  v_add_f32 v34, v34, v82
  v_add_f32 v35, v35, v83
  v_add_f32 v32, v32, v84
  v_add_f32 v33, v33, v85
  v_add_f32 v34, v34, v86
  v_add_f32 v35, v35, v87
  v_add_f32 v32, v32, v88
  v_add_f32 v33, v33, v89
  v_add_f32 v34, v34, v90
  v_add_f32 v35, v35, v91
  v_add_f32 v32, v32, v92
  v_add_f32 v33, v33, v93
  v_add_f32 v34, v34, v94
  v_add_f32 v35, v35, v95
  v_add_f32 v36, v96, v100
  v_add_f32 v37, v97, v101
  v_add_f32 v38, v98, v102
  v_add_f32 v39, v99, v103
  v_add_f32 v36, v36, v104
  v_add_f32 v37, v37, v105
  v_add_f32 v38, v38, v106
  v_add_f32 v39, v39, v107
  v_add_f32 v36, v36, v108
  v_add_f32 v37, v37, v109
  v_add_f32 v38, v38, v110
  v_add_f32 v39, v39, v111
  v_add_f32 v36, v36, v112
  v_add_f32 v37, v37, v113
  v_add_f32 v38, v38, v114
  v_add_f32 v39, v39, v115
  v_add_f32 v36, v36, v116
  v_add_f32 v37, v37, v117
  v_add_f32 v38, v38, v118
  v_add_f32 v39, v39, v119
  v_add_f32 v36, v36, v120
  v_add_f32 v37, v37, v121
  v_add_f32 v38, v38, v122
  v_add_f32 v39, v39, v123
  v_add_f32 v36, v36, v124
  v_add_f32 v37, v37, v125
  v_add_f32 v38, v38, v126
  v_add_f32 v39, v39, v127
  v_permlane32_swap_b32 v32, v36
  v_permlane32_swap_b32 v33, v37
  v_permlane32_swap_b32 v34, v38
  v_permlane32_swap_b32 v35, v39
  v_add_f32 v40, v32, v36
  v_add_f32 v41, v33, v37
  v_mov_b32 v42, s74
  v_mov_b32 v43, s75
  v_add_f32 v44, v34, v38
  v_add_f32 v45, v35, v39
  v_mov_b32 v46, s74
  v_mov_b32 v47, s75
  s_waitcnt vmcnt(13)
  buffer_store_dwordx4 v[40:43], v56, s[60:63], 0 offen
  buffer_store_dwordx4 v[44:47], v56, s[60:63], 0 offen offset:256
  ds_read_b128 v[64:67], v14 offset:2048
  ds_read_b128 v[68:71], v14 offset:6144
  ds_read_b128 v[72:75], v14 offset:10240
  ds_read_b128 v[76:79], v14 offset:14336
  ds_read_b128 v[80:83], v14 offset:18432
  ds_read_b128 v[84:87], v14 offset:22528
  ds_read_b128 v[88:91], v14 offset:26624
  ds_read_b128 v[92:95], v14 offset:30720
  ds_read_b128 v[96:99], v14 offset:3072
  ds_read_b128 v[100:103], v14 offset:7168
  ds_read_b128 v[104:107], v14 offset:11264
  ds_read_b128 v[108:111], v14 offset:15360
  ds_read_b128 v[112:115], v14 offset:19456
  ds_read_b128 v[116:119], v14 offset:23552
  ds_read_b128 v[120:123], v14 offset:27648
  ds_read_b128 v[124:127], v14 offset:31744
  s_waitcnt lgkmcnt(0)
  v_add_f32 v32, v64, v68
  v_add_f32 v33, v65, v69
  v_add_f32 v34, v66, v70
  v_add_f32 v35, v67, v71
  v_add_f32 v32, v32, v72
  v_add_f32 v33, v33, v73
  v_add_f32 v34, v34, v74
  v_add_f32 v35, v35, v75
  v_add_f32 v32, v32, v76
  v_add_f32 v33, v33, v77
  v_add_f32 v34, v34, v78
  v_add_f32 v35, v35, v79
  v_add_f32 v32, v32, v80
  v_add_f32 v33, v33, v81
  v_add_f32 v34, v34, v82
  v_add_f32 v35, v35, v83
  v_add_f32 v32, v32, v84
  v_add_f32 v33, v33, v85
  v_add_f32 v34, v34, v86
  v_add_f32 v35, v35, v87
  v_add_f32 v32, v32, v88
  v_add_f32 v33, v33, v89
  v_add_f32 v34, v34, v90
  v_add_f32 v35, v35, v91
  v_add_f32 v32, v32, v92
  v_add_f32 v33, v33, v93
  v_add_f32 v34, v34, v94
  v_add_f32 v35, v35, v95
  v_add_f32 v36, v96, v100
  v_add_f32 v37, v97, v101
  v_add_f32 v38, v98, v102
  v_add_f32 v39, v99, v103
  v_add_f32 v36, v36, v104
  v_add_f32 v37, v37, v105
  v_add_f32 v38, v38, v106
  v_add_f32 v39, v39, v107
  v_add_f32 v36, v36, v108
  v_add_f32 v37, v37, v109
  v_add_f32 v38, v38, v110
  v_add_f32 v39, v39, v111
  v_add_f32 v36, v36, v112
  v_add_f32 v37, v37, v113
  v_add_f32 v38, v38, v114
  v_add_f32 v39, v39, v115
  v_add_f32 v36, v36, v116
  v_add_f32 v37, v37, v117
  v_add_f32 v38, v38, v118
  v_add_f32 v39, v39, v119
  v_add_f32 v36, v36, v120
  v_add_f32 v37, v37, v121
  v_add_f32 v38, v38, v122
  v_add_f32 v39, v39, v123
  v_add_f32 v36, v36, v124
  v_add_f32 v37, v37, v125
  v_add_f32 v38, v38, v126
  v_add_f32 v39, v39, v127
  v_permlane32_swap_b32 v32, v36
  v_permlane32_swap_b32 v33, v37
  v_permlane32_swap_b32 v34, v38
  v_permlane32_swap_b32 v35, v39
  v_add_f32 v48, v32, v36
  v_add_f32 v49, v33, v37
  v_mov_b32 v50, s74
  v_mov_b32 v51, s75
  v_add_f32 v52, v34, v38
  v_add_f32 v53, v35, v39
  v_mov_b32 v54, s74
  v_mov_b32 v55, s75
  buffer_store_dwordx4 v[48:51], v57, s[60:63], 0 offen
  buffer_store_dwordx4 v[52:55], v57, s[60:63], 0 offen offset:256
  s_lshl_b32 s13, s4, 3
  s_add_u32 s13, s13, s6
  s_lshl_b32 s13, s13, 14
  v_lshlrev_b32 v14, 9, v2
  v_lshl_add_u32 v14, v3, 4, v14
  v_add_u32 v14, s13, v14
  v_lshlrev_b32 v15, 7, v2
  v_bfe_u32 v10, v1, 2, 1
  v_lshl_add_u32 v15, v10, 6, v15
  v_bfe_u32 v10, v1, 3, 1
  v_lshl_add_u32 v15, v10, 3, v15
  v_and_b32 v10, 3, v1
  v_lshl_add_u32 v15, v10, 1, v15
  s_mov_b64 s[0:1], -1
  s_mov_b64 s[24:25], -1
  s_mov_b64 s[26:27], -1
  s_mov_b64 s[28:29], -1
  s_mov_b64 s[30:31], -1
  s_mov_b64 s[56:57], -1
  s_mov_b64 s[58:59], -1
  s_mov_b64 s[14:15], -1
  s_mov_b32 s73, 200000
L_poll0:
  s_mov_b64 exec, s[0:1]
  s_cbranch_execz L_poll0_s0
  buffer_load_dwordx4 v[64:67], v14, s[60:63], 0 offen offset:0 sc1
  buffer_load_dwordx4 v[68:71], v14, s[60:63], 0 offen offset:256 sc1
L_poll0_s0:
  s_mov_b64 exec, s[24:25]
  s_cbranch_execz L_poll0_s1
  buffer_load_dwordx4 v[72:75], v14, s[60:63], 0 offen offset:2048 sc1
  buffer_load_dwordx4 v[76:79], v14, s[60:63], 0 offen offset:2304 sc1
L_poll0_s1:
  s_mov_b64 exec, s[26:27]
  s_cbranch_execz L_poll0_s2
  buffer_load_dwordx4 v[80:83], v14, s[60:63], s65 offen offset:0 sc1
  buffer_load_dwordx4 v[84:87], v14, s[60:63], s65 offen offset:256 sc1
L_poll0_s2:
  s_mov_b64 exec, s[28:29]
  s_cbranch_execz L_poll0_s3
  buffer_load_dwordx4 v[88:91], v14, s[60:63], s65 offen offset:2048 sc1
  buffer_load_dwordx4 v[92:95], v14, s[60:63], s65 offen offset:2304 sc1
L_poll0_s3:
  s_mov_b64 exec, s[30:31]
  s_cbranch_execz L_poll0_s4
  buffer_load_dwordx4 v[96:99], v14, s[60:63], s66 offen offset:0 sc1
  buffer_load_dwordx4 v[100:103], v14, s[60:63], s66 offen offset:256 sc1
L_poll0_s4:
  s_mov_b64 exec, s[56:57]
  s_cbranch_execz L_poll0_s5
  buffer_load_dwordx4 v[104:107], v14, s[60:63], s66 offen offset:2048 sc1
  buffer_load_dwordx4 v[108:111], v14, s[60:63], s66 offen offset:2304 sc1
L_poll0_s5:
  s_mov_b64 exec, s[58:59]
  s_cbranch_execz L_poll0_s6
  buffer_load_dwordx4 v[112:115], v14, s[60:63], s67 offen offset:0 sc1
  buffer_load_dwordx4 v[116:119], v14, s[60:63], s67 offen offset:256 sc1
L_poll0_s6:
  s_mov_b64 exec, s[14:15]
  s_cbranch_execz L_poll0_s7
  buffer_load_dwordx4 v[120:123], v14, s[60:63], s67 offen offset:2048 sc1
  buffer_load_dwordx4 v[124:127], v14, s[60:63], s67 offen offset:2304 sc1
L_poll0_s7:
  s_waitcnt vmcnt(0)
  s_mov_b64 exec, s[0:1]
  v_xor_b32 v66, s74, v66
  v_xor_b32 v67, s75, v67
  v_xor_b32 v70, s74, v70
  v_xor_b32 v71, s75, v71
  v_or3_b32 v10, v66, v67, v70
  v_or_b32 v10, v10, v71
  v_cmp_ne_u32 s[0:1], 0, v10
  s_mov_b64 exec, s[24:25]
  v_xor_b32 v74, s74, v74
  v_xor_b32 v75, s75, v75
  v_xor_b32 v78, s74, v78
  v_xor_b32 v79, s75, v79
  v_or3_b32 v11, v74, v75, v78
  v_or_b32 v11, v11, v79
  v_cmp_ne_u32 s[24:25], 0, v11
  s_mov_b64 exec, s[26:27]
  v_xor_b32 v82, s74, v82
  v_xor_b32 v83, s75, v83
  v_xor_b32 v86, s74, v86
  v_xor_b32 v87, s75, v87
  v_or3_b32 v10, v82, v83, v86
  v_or_b32 v10, v10, v87
  v_cmp_ne_u32 s[26:27], 0, v10
  s_mov_b64 exec, s[28:29]
  v_xor_b32 v90, s74, v90
  v_xor_b32 v91, s75, v91
  v_xor_b32 v94, s74, v94
  v_xor_b32 v95, s75, v95
  v_or3_b32 v11, v90, v91, v94
  v_or_b32 v11, v11, v95
  v_cmp_ne_u32 s[28:29], 0, v11
  s_mov_b64 exec, s[30:31]
  v_xor_b32 v98, s74, v98
  v_xor_b32 v99, s75, v99
  v_xor_b32 v102, s74, v102
  v_xor_b32 v103, s75, v103
  v_or3_b32 v10, v98, v99, v102
  v_or_b32 v10, v10, v103
  v_cmp_ne_u32 s[30:31], 0, v10
  s_mov_b64 exec, s[56:57]
  v_xor_b32 v106, s74, v106
  v_xor_b32 v107, s75, v107
  v_xor_b32 v110, s74, v110
  v_xor_b32 v111, s75, v111
  v_or3_b32 v11, v106, v107, v110
  v_or_b32 v11, v11, v111
  v_cmp_ne_u32 s[56:57], 0, v11
  s_mov_b64 exec, s[58:59]
  v_xor_b32 v114, s74, v114
  v_xor_b32 v115, s75, v115
  v_xor_b32 v118, s74, v118
  v_xor_b32 v119, s75, v119
  v_or3_b32 v10, v114, v115, v118
  v_or_b32 v10, v10, v119
  v_cmp_ne_u32 s[58:59], 0, v10
  s_mov_b64 exec, s[14:15]
  v_xor_b32 v122, s74, v122
  v_xor_b32 v123, s75, v123
  v_xor_b32 v126, s74, v126
  v_xor_b32 v127, s75, v127
  v_or3_b32 v11, v122, v123, v126
  v_or_b32 v11, v11, v127
  v_cmp_ne_u32 s[14:15], 0, v11
  s_mov_b64 exec, -1
  s_or_b64 vcc, s[0:1], s[24:25]
  s_or_b64 vcc, vcc, s[26:27]
  s_or_b64 vcc, vcc, s[28:29]
  s_or_b64 vcc, vcc, s[30:31]
  s_or_b64 vcc, vcc, s[56:57]
  s_or_b64 vcc, vcc, s[58:59]
  s_or_b64 vcc, vcc, s[14:15]
  s_cbranch_scc0 L_poll0_done
  s_sleep 2
  s_cmp_lg_u32 s73, 199984
  s_cbranch_scc1 L_poll0_nohook
  buffer_store_dwordx4 v[40:43], v56, s[60:63], s12 offen sc1
  buffer_store_dwordx4 v[44:47], v56, s[60:63], s12 offen offset:256 sc1
  buffer_store_dwordx4 v[48:51], v57, s[60:63], s12 offen sc1
  buffer_store_dwordx4 v[52:55], v57, s[60:63], s12 offen offset:256 sc1
L_poll0_nohook:
  s_cmp_le_u32 s73, 199984
  s_cselect_b32 s13, 4194304, 0
  v_xor_b32 v14, s13, v14
  s_sub_u32 s73, s73, 1
  s_cmp_lg_u32 s73, 0
  s_cbranch_scc1 L_poll0
L_poll0_done:
  s_cmp_lt_u32 s73, 199984
  s_cbranch_scc1 L_poll0_nohook2
  buffer_store_dwordx4 v[40:43], v56, s[60:63], s12 offen sc1
  buffer_store_dwordx4 v[44:47], v56, s[60:63], s12 offen offset:256 sc1
  buffer_store_dwordx4 v[48:51], v57, s[60:63], s12 offen sc1
  buffer_store_dwordx4 v[52:55], v57, s[60:63], s12 offen offset:256 sc1
L_poll0_nohook2:
  v_add_f32 v32, v64, v80
  v_add_f32 v33, v65, v81
  v_add_f32 v34, v68, v84
  v_add_f32 v35, v69, v85
  v_add_f32 v32, v32, v96
  v_add_f32 v33, v33, v97
  v_add_f32 v34, v34, v100
  v_add_f32 v35, v35, v101
  v_add_f32 v32, v32, v112
  v_add_f32 v33, v33, v113
  v_add_f32 v34, v34, v116
  v_add_f32 v35, v35, v117
  v_cvt_pk_bf16_f32 v60, v32, v33
  v_cvt_pk_bf16_f32 v61, v34, v35
  ds_write_b16 v15, v60 offset:49408
  ds_write_b16_d16_hi v15, v60 offset:49424
  ds_write_b16 v15, v61 offset:49440
  ds_write_b16_d16_hi v15, v61 offset:49456
  v_add_f32 v36, v72, v88
  v_add_f32 v37, v73, v89
  v_add_f32 v38, v76, v92
  v_add_f32 v39, v77, v93
  v_add_f32 v36, v36, v104
  v_add_f32 v37, v37, v105
  v_add_f32 v38, v38, v108
  v_add_f32 v39, v39, v109
  v_add_f32 v36, v36, v120
  v_add_f32 v37, v37, v121
  v_add_f32 v38, v38, v124
  v_add_f32 v39, v39, v125
  v_cvt_pk_bf16_f32 v62, v36, v37
  v_cvt_pk_bf16_f32 v63, v38, v39
  ds_write_b16 v15, v62 offset:49920
  ds_write_b16_d16_hi v15, v62 offset:49936
  ds_write_b16 v15, v63 offset:49952
  ds_write_b16_d16_hi v15, v63 offset:49968
  buffer_load_dwordx4 v[192:195], v4, s[36:39], s20 offen offset:0 nt
  buffer_load_dwordx4 v[196:199], v4, s[36:39], s20 offen offset:128 nt
  buffer_load_dwordx4 v[200:203], v4, s[36:39], s20 offen offset:512 nt
  buffer_load_dwordx4 v[204:207], v4, s[36:39], s20 offen offset:640 nt
  s_waitcnt lgkmcnt(0)
  s_barrier
  s_branch L_main
L_others:
  s_waitcnt vmcnt(2)
  buffer_load_dwordx4 v[140:143], v4, s[36:39], s16 offen offset:640 nt
  s_waitcnt vmcnt(2)
  buffer_load_dwordx4 v[144:147], v4, s[36:39], s17 offen offset:0 nt
  s_waitcnt vmcnt(2)
  buffer_load_dwordx4 v[148:151], v4, s[36:39], s17 offen offset:128 nt
  s_waitcnt vmcnt(2)
  buffer_load_dwordx4 v[152:155], v4, s[36:39], s17 offen offset:512 nt
  s_waitcnt vmcnt(2)
  buffer_load_dwordx4 v[156:159], v4, s[36:39], s17 offen offset:640 nt
  s_waitcnt vmcnt(2)
  buffer_load_dwordx4 v[160:163], v4, s[36:39], s18 offen offset:0 nt
  s_cmp_ge_u32 s3, 4
  s_cselect_b32 exec_lo, -1, 0
  s_cselect_b32 exec_hi, -1, 0
  buffer_load_dwordx4 v[32:35], v12, s[48:51], 0 offen nt
  buffer_load_dwordx4 v[36:39], v12, s[48:51], s66 offen nt
  buffer_load_dwordx4 v[40:43], v12, s[48:51], s68 offen nt
  buffer_load_dwordx4 v[44:47], v12, s[48:51], s70 offen nt
  s_mov_b64 exec, -1
  s_waitcnt vmcnt(2)
  buffer_load_dwordx4 v[164:167], v4, s[36:39], s18 offen offset:128 nt
  s_waitcnt vmcnt(2)
  buffer_load_dwordx4 v[168:171], v4, s[36:39], s18 offen offset:512 nt
  s_waitcnt vmcnt(2)
  buffer_load_dwordx4 v[172:175], v4, s[36:39], s18 offen offset:640 nt
  s_waitcnt vmcnt(2)
  buffer_load_dwordx4 v[176:179], v4, s[36:39], s19 offen offset:0 nt
  s_waitcnt vmcnt(2)
  buffer_load_dwordx4 v[180:183], v4, s[36:39], s19 offen offset:128 nt
  s_waitcnt vmcnt(2)
  buffer_load_dwordx4 v[184:187], v4, s[36:39], s19 offen offset:512 nt
  s_waitcnt vmcnt(2)
  buffer_load_dwordx4 v[188:191], v4, s[36:39], s19 offen offset:640 nt
  s_waitcnt vmcnt(2)
  buffer_load_dwordx4 v[192:195], v4, s[36:39], s20 offen offset:0 nt
  s_waitcnt vmcnt(2)
  buffer_load_dwordx4 v[196:199], v4, s[36:39], s20 offen offset:128 nt
  s_waitcnt vmcnt(2)
  buffer_load_dwordx4 v[200:203], v4, s[36:39], s20 offen offset:512 nt
  s_waitcnt vmcnt(2)
  buffer_load_dwordx4 v[204:207], v4, s[36:39], s20 offen offset:640 nt
  s_waitcnt vmcnt(11)
  s_cmp_ge_u32 s3, 4
  s_cselect_b32 exec_lo, -1, 0
  s_cselect_b32 exec_hi, -1, 0
  ds_write_b128 v13, v[32:35] offset:0
  ds_write_b128 v13, v[36:39] offset:1024
  ds_write_b128 v13, v[40:43] offset:2048
  ds_write_b128 v13, v[44:47] offset:3072
  s_mov_b64 exec, -1
  s_waitcnt lgkmcnt(0)
  s_barrier
L_main:
  s_waitcnt vmcnt(3)
  buffer_load_dwordx4 v[208:211], v4, s[36:39], s21 offen offset:0 nt
  v_lshrrev_b32 v14, 2, v3
  v_lshlrev_b32 v14, 8, v14
  v_lshl_add_u32 v14, v2, 4, v14
  v_and_b32 v15, 1, v1
  v_lshl_add_u32 v14, v15, 6, v14
  ds_read_b128 v[16:19], v14 offset:49408
  ds_read_b128 v[20:23], v14 offset:49536
  s_mov_b32 s24, 0x3db504f3
  s_mov_b32 s25, 0xffff0000
  s_mov_b32 s26, 0x3fb8aa3b
  s_waitcnt lgkmcnt(0)
  s_waitcnt vmcnt(17)
  v_mfma_f32_16x16x32_bf16 v[32:35], v[128:131], v[16:19], 0
  v_mfma_f32_16x16x32_bf16 v[32:35], v[132:135], v[20:23], v[32:35]
  v_mfma_f32_16x16x32_bf16 v[24:27], v[136:139], v[16:19], 0
  v_mfma_f32_16x16x32_bf16 v[24:27], v[140:143], v[20:23], v[24:27]
  s_waitcnt vmcnt(13)
  v_mfma_f32_16x16x32_bf16 v[36:39], v[144:147], v[16:19], 0
  v_mfma_f32_16x16x32_bf16 v[36:39], v[148:151], v[20:23], v[36:39]
  v_mfma_f32_16x16x32_bf16 v[28:31], v[152:155], v[16:19], 0
  v_mfma_f32_16x16x32_bf16 v[28:31], v[156:159], v[20:23], v[28:31]
  s_waitcnt vmcnt(3)
  buffer_load_dwordx4 v[212:215], v4, s[36:39], s21 offen offset:128 nt
  s_nop 0
  v_permlane32_swap_b32 v32, v24
  v_permlane32_swap_b32 v33, v25
  v_permlane32_swap_b32 v34, v26
  v_permlane32_swap_b32 v35, v27
  v_mov_b32_dpp v32, v32 quad_perm:[0,0,2,2] row_mask:0xf bank_mask:0xf
  v_mov_b32_dpp v33, v33 quad_perm:[0,0,2,2] row_mask:0xf bank_mask:0xf
  v_mov_b32_dpp v34, v34 quad_perm:[0,0,2,2] row_mask:0xf bank_mask:0xf
  v_mov_b32_dpp v35, v35 quad_perm:[0,0,2,2] row_mask:0xf bank_mask:0xf
  v_add_f32_dpp v32, v24, v32 quad_perm:[1,1,3,3] row_mask:0xf bank_mask:0xf
  v_add_f32_dpp v33, v25, v33 quad_perm:[1,1,3,3] row_mask:0xf bank_mask:0xf
  v_add_f32_dpp v34, v26, v34 quad_perm:[1,1,3,3] row_mask:0xf bank_mask:0xf
  v_add_f32_dpp v35, v27, v35 quad_perm:[1,1,3,3] row_mask:0xf bank_mask:0xf
  v_cvt_pk_bf16_f32 v10, v32, v33
  v_cvt_pk_bf16_f32 v11, v34, v35
  v_lshlrev_b32 v32, 16, v10
  v_lshlrev_b32 v34, 16, v11
  v_and_b32 v33, s25, v10
  v_and_b32 v35, s25, v11
  v_mul_f32 v32, s24, v32
  v_mul_f32 v34, s24, v34
  v_mul_f32 v33, s24, v33
  v_mul_f32 v35, s24, v35
  v_cvt_pk_bf16_f32 v10, v32, v33
  v_cvt_pk_bf16_f32 v11, v34, v35
  v_lshlrev_b32 v32, 16, v10
  v_lshlrev_b32 v34, 16, v11
  v_and_b32 v33, s25, v10
  v_and_b32 v35, s25, v11
  v_max3_f32 v8, v32, v33, v34
  v_max_f32 v8, v8, v35
  s_waitcnt vmcnt(10)
  v_mfma_f32_16x16x32_bf16 v[40:43], v[160:163], v[16:19], 0
  v_mfma_f32_16x16x32_bf16 v[40:43], v[164:167], v[20:23], v[40:43]
  v_mfma_f32_16x16x32_bf16 v[24:27], v[168:171], v[16:19], 0
  v_mfma_f32_16x16x32_bf16 v[24:27], v[172:175], v[20:23], v[24:27]
  s_waitcnt vmcnt(3)
  buffer_load_dwordx4 v[216:219], v4, s[36:39], s21 offen offset:512 nt
  v_permlane32_swap_b32 v36, v28
  v_permlane32_swap_b32 v37, v29
  v_permlane32_swap_b32 v38, v30
  v_permlane32_swap_b32 v39, v31
  v_mov_b32_dpp v36, v36 quad_perm:[0,0,2,2] row_mask:0xf bank_mask:0xf
  v_mov_b32_dpp v37, v37 quad_perm:[0,0,2,2] row_mask:0xf bank_mask:0xf
  v_mov_b32_dpp v38, v38 quad_perm:[0,0,2,2] row_mask:0xf bank_mask:0xf
  v_mov_b32_dpp v39, v39 quad_perm:[0,0,2,2] row_mask:0xf bank_mask:0xf
  v_add_f32_dpp v36, v28, v36 quad_perm:[1,1,3,3] row_mask:0xf bank_mask:0xf
  v_add_f32_dpp v37, v29, v37 quad_perm:[1,1,3,3] row_mask:0xf bank_mask:0xf
  v_add_f32_dpp v38, v30, v38 quad_perm:[1,1,3,3] row_mask:0xf bank_mask:0xf
  v_add_f32_dpp v39, v31, v39 quad_perm:[1,1,3,3] row_mask:0xf bank_mask:0xf
  v_cvt_pk_bf16_f32 v10, v36, v37
  v_cvt_pk_bf16_f32 v11, v38, v39
  v_lshlrev_b32 v36, 16, v10
  v_lshlrev_b32 v38, 16, v11
  v_and_b32 v37, s25, v10
  v_and_b32 v39, s25, v11
  v_mul_f32 v36, s24, v36
  v_mul_f32 v38, s24, v38
  v_mul_f32 v37, s24, v37
  v_mul_f32 v39, s24, v39
  v_cvt_pk_bf16_f32 v10, v36, v37
  v_cvt_pk_bf16_f32 v11, v38, v39
  v_lshlrev_b32 v36, 16, v10
  v_lshlrev_b32 v38, 16, v11
  v_and_b32 v37, s25, v10
  v_and_b32 v39, s25, v11
  v_max3_f32 v8, v8, v36, v37
  v_max3_f32 v8, v8, v38, v39
  s_waitcnt vmcnt(7)
  v_mfma_f32_16x16x32_bf16 v[44:47], v[176:179], v[16:19], 0
  v_mfma_f32_16x16x32_bf16 v[44:47], v[180:183], v[20:23], v[44:47]
  v_mfma_f32_16x16x32_bf16 v[28:31], v[184:187], v[16:19], 0
  v_mfma_f32_16x16x32_bf16 v[28:31], v[188:191], v[20:23], v[28:31]
  s_waitcnt vmcnt(3)
  buffer_load_dwordx4 v[220:223], v4, s[36:39], s21 offen offset:640 nt
  v_permlane32_swap_b32 v40, v24
  v_permlane32_swap_b32 v41, v25
  v_permlane32_swap_b32 v42, v26
  v_permlane32_swap_b32 v43, v27
  v_mov_b32_dpp v40, v40 quad_perm:[0,0,2,2] row_mask:0xf bank_mask:0xf
  v_mov_b32_dpp v41, v41 quad_perm:[0,0,2,2] row_mask:0xf bank_mask:0xf
  v_mov_b32_dpp v42, v42 quad_perm:[0,0,2,2] row_mask:0xf bank_mask:0xf
  v_mov_b32_dpp v43, v43 quad_perm:[0,0,2,2] row_mask:0xf bank_mask:0xf
  v_add_f32_dpp v40, v24, v40 quad_perm:[1,1,3,3] row_mask:0xf bank_mask:0xf
  v_add_f32_dpp v41, v25, v41 quad_perm:[1,1,3,3] row_mask:0xf bank_mask:0xf
  v_add_f32_dpp v42, v26, v42 quad_perm:[1,1,3,3] row_mask:0xf bank_mask:0xf
  v_add_f32_dpp v43, v27, v43 quad_perm:[1,1,3,3] row_mask:0xf bank_mask:0xf
  v_cvt_pk_bf16_f32 v10, v40, v41
  v_cvt_pk_bf16_f32 v11, v42, v43
  v_lshlrev_b32 v40, 16, v10
  v_lshlrev_b32 v42, 16, v11
  v_and_b32 v41, s25, v10
  v_and_b32 v43, s25, v11
  v_mul_f32 v40, s24, v40
  v_mul_f32 v42, s24, v42
  v_mul_f32 v41, s24, v41
  v_mul_f32 v43, s24, v43
  v_cvt_pk_bf16_f32 v10, v40, v41
  v_cvt_pk_bf16_f32 v11, v42, v43
  v_lshlrev_b32 v40, 16, v10
  v_lshlrev_b32 v42, 16, v11
  v_and_b32 v41, s25, v10
  v_and_b32 v43, s25, v11
  v_max3_f32 v8, v8, v40, v41
  v_max3_f32 v8, v8, v42, v43
  s_waitcnt vmcnt(4)
  v_mfma_f32_16x16x32_bf16 v[48:51], v[192:195], v[16:19], 0
  v_mfma_f32_16x16x32_bf16 v[48:51], v[196:199], v[20:23], v[48:51]
  v_mfma_f32_16x16x32_bf16 v[24:27], v[200:203], v[16:19], 0
  v_mfma_f32_16x16x32_bf16 v[24:27], v[204:207], v[20:23], v[24:27]
  s_waitcnt vmcnt(3)
  buffer_load_dwordx4 v[224:227], v4, s[36:39], s22 offen offset:0 nt
  v_permlane32_swap_b32 v44, v28
  v_permlane32_swap_b32 v45, v29
  v_permlane32_swap_b32 v46, v30
  v_permlane32_swap_b32 v47, v31
  v_mov_b32_dpp v44, v44 quad_perm:[0,0,2,2] row_mask:0xf bank_mask:0xf
  v_mov_b32_dpp v45, v45 quad_perm:[0,0,2,2] row_mask:0xf bank_mask:0xf
  v_mov_b32_dpp v46, v46 quad_perm:[0,0,2,2] row_mask:0xf bank_mask:0xf
  v_mov_b32_dpp v47, v47 quad_perm:[0,0,2,2] row_mask:0xf bank_mask:0xf
  v_add_f32_dpp v44, v28, v44 quad_perm:[1,1,3,3] row_mask:0xf bank_mask:0xf
  v_add_f32_dpp v45, v29, v45 quad_perm:[1,1,3,3] row_mask:0xf bank_mask:0xf
  v_add_f32_dpp v46, v30, v46 quad_perm:[1,1,3,3] row_mask:0xf bank_mask:0xf
  v_add_f32_dpp v47, v31, v47 quad_perm:[1,1,3,3] row_mask:0xf bank_mask:0xf
  v_cvt_pk_bf16_f32 v10, v44, v45
  v_cvt_pk_bf16_f32 v11, v46, v47
  v_lshlrev_b32 v44, 16, v10
  v_lshlrev_b32 v46, 16, v11
  v_and_b32 v45, s25, v10
  v_and_b32 v47, s25, v11
  v_mul_f32 v44, s24, v44
  v_mul_f32 v46, s24, v46
  v_mul_f32 v45, s24, v45
  v_mul_f32 v47, s24, v47
  v_cvt_pk_bf16_f32 v10, v44, v45
  v_cvt_pk_bf16_f32 v11, v46, v47
  v_lshlrev_b32 v44, 16, v10
  v_lshlrev_b32 v46, 16, v11
  v_and_b32 v45, s25, v10
  v_and_b32 v47, s25, v11
  v_max3_f32 v8, v8, v44, v45
  v_max3_f32 v8, v8, v46, v47
  s_waitcnt vmcnt(3)
  buffer_load_dwordx4 v[228:231], v4, s[36:39], s22 offen offset:128 nt
  s_waitcnt vmcnt(3)
  buffer_load_dwordx4 v[232:235], v4, s[36:39], s22 offen offset:512 nt
  s_waitcnt vmcnt(3)
  buffer_load_dwordx4 v[236:239], v4, s[36:39], s22 offen offset:640 nt
  s_waitcnt vmcnt(4)
  v_mfma_f32_16x16x32_bf16 v[52:55], v[208:211], v[16:19], 0
  v_mfma_f32_16x16x32_bf16 v[52:55], v[212:215], v[20:23], v[52:55]
  v_mfma_f32_16x16x32_bf16 v[28:31], v[216:219], v[16:19], 0
  v_mfma_f32_16x16x32_bf16 v[28:31], v[220:223], v[20:23], v[28:31]
  v_permlane32_swap_b32 v48, v24
  v_permlane32_swap_b32 v49, v25
  v_permlane32_swap_b32 v50, v26
  v_permlane32_swap_b32 v51, v27
  v_mov_b32_dpp v48, v48 quad_perm:[0,0,2,2] row_mask:0xf bank_mask:0xf
  v_mov_b32_dpp v49, v49 quad_perm:[0,0,2,2] row_mask:0xf bank_mask:0xf
  v_mov_b32_dpp v50, v50 quad_perm:[0,0,2,2] row_mask:0xf bank_mask:0xf
  v_mov_b32_dpp v51, v51 quad_perm:[0,0,2,2] row_mask:0xf bank_mask:0xf
  v_add_f32_dpp v48, v24, v48 quad_perm:[1,1,3,3] row_mask:0xf bank_mask:0xf
  v_add_f32_dpp v49, v25, v49 quad_perm:[1,1,3,3] row_mask:0xf bank_mask:0xf
  v_add_f32_dpp v50, v26, v50 quad_perm:[1,1,3,3] row_mask:0xf bank_mask:0xf
  v_add_f32_dpp v51, v27, v51 quad_perm:[1,1,3,3] row_mask:0xf bank_mask:0xf
  v_cvt_pk_bf16_f32 v10, v48, v49
  v_cvt_pk_bf16_f32 v11, v50, v51
  v_lshlrev_b32 v48, 16, v10
  v_lshlrev_b32 v50, 16, v11
  v_and_b32 v49, s25, v10
  v_and_b32 v51, s25, v11
  v_mul_f32 v48, s24, v48
  v_mul_f32 v50, s24, v50
  v_mul_f32 v49, s24, v49
  v_mul_f32 v51, s24, v51
  v_cvt_pk_bf16_f32 v10, v48, v49
  v_cvt_pk_bf16_f32 v11, v50, v51
  v_lshlrev_b32 v48, 16, v10
  v_lshlrev_b32 v50, 16, v11
  v_and_b32 v49, s25, v10
  v_and_b32 v51, s25, v11
  v_max3_f32 v8, v8, v48, v49
  v_max3_f32 v8, v8, v50, v51
  s_waitcnt vmcnt(3)
  buffer_load_dwordx4 v[240:243], v4, s[36:39], s23 offen offset:0 nt
  s_waitcnt vmcnt(3)
  buffer_load_dwordx4 v[244:247], v4, s[36:39], s23 offen offset:128 nt
  s_waitcnt vmcnt(3)
  buffer_load_dwordx4 v[248:251], v4, s[36:39], s23 offen offset:512 nt
  s_waitcnt vmcnt(3)
  buffer_load_dwordx4 v[252:255], v4, s[36:39], s23 offen offset:640 nt
  s_waitcnt vmcnt(4)
  v_mfma_f32_16x16x32_bf16 v[56:59], v[224:227], v[16:19], 0
  v_mfma_f32_16x16x32_bf16 v[56:59], v[228:231], v[20:23], v[56:59]
  v_mfma_f32_16x16x32_bf16 v[24:27], v[232:235], v[16:19], 0
  v_mfma_f32_16x16x32_bf16 v[24:27], v[236:239], v[20:23], v[24:27]
  v_permlane32_swap_b32 v52, v28
  v_permlane32_swap_b32 v53, v29
  v_permlane32_swap_b32 v54, v30
  v_permlane32_swap_b32 v55, v31
  v_mov_b32_dpp v52, v52 quad_perm:[0,0,2,2] row_mask:0xf bank_mask:0xf
  v_mov_b32_dpp v53, v53 quad_perm:[0,0,2,2] row_mask:0xf bank_mask:0xf
  v_mov_b32_dpp v54, v54 quad_perm:[0,0,2,2] row_mask:0xf bank_mask:0xf
  v_mov_b32_dpp v55, v55 quad_perm:[0,0,2,2] row_mask:0xf bank_mask:0xf
  v_add_f32_dpp v52, v28, v52 quad_perm:[1,1,3,3] row_mask:0xf bank_mask:0xf
  v_add_f32_dpp v53, v29, v53 quad_perm:[1,1,3,3] row_mask:0xf bank_mask:0xf
  v_add_f32_dpp v54, v30, v54 quad_perm:[1,1,3,3] row_mask:0xf bank_mask:0xf
  v_add_f32_dpp v55, v31, v55 quad_perm:[1,1,3,3] row_mask:0xf bank_mask:0xf
  v_cvt_pk_bf16_f32 v10, v52, v53
  v_cvt_pk_bf16_f32 v11, v54, v55
  v_lshlrev_b32 v52, 16, v10
  v_lshlrev_b32 v54, 16, v11
  v_and_b32 v53, s25, v10
  v_and_b32 v55, s25, v11
  v_mul_f32 v52, s24, v52
  v_mul_f32 v54, s24, v54
  v_mul_f32 v53, s24, v53
  v_mul_f32 v55, s24, v55
  v_cvt_pk_bf16_f32 v10, v52, v53
  v_cvt_pk_bf16_f32 v11, v54, v55
  v_lshlrev_b32 v52, 16, v10
  v_lshlrev_b32 v54, 16, v11
  v_and_b32 v53, s25, v10
  v_and_b32 v55, s25, v11
  v_max3_f32 v8, v8, v52, v53
  v_max3_f32 v8, v8, v54, v55
  s_waitcnt vmcnt(3)
  buffer_load_dwordx4 v[64:67], v5, s[40:43], s16 offen offset:0 nt
  s_waitcnt vmcnt(3)
  buffer_load_dwordx4 v[68:71], v5, s[40:43], s16 offen offset:1024 nt
  s_waitcnt vmcnt(3)
  buffer_load_dwordx4 v[72:75], v5, s[40:43], s16 offen offset:2048 nt
  s_waitcnt vmcnt(3)
  buffer_load_dwordx4 v[76:79], v5, s[40:43], s16 offen offset:3072 nt
  s_waitcnt vmcnt(4)
  v_mfma_f32_16x16x32_bf16 v[60:63], v[240:243], v[16:19], 0
  v_mfma_f32_16x16x32_bf16 v[60:63], v[244:247], v[20:23], v[60:63]
  v_mfma_f32_16x16x32_bf16 v[28:31], v[248:251], v[16:19], 0
  v_mfma_f32_16x16x32_bf16 v[28:31], v[252:255], v[20:23], v[28:31]
  v_permlane32_swap_b32 v56, v24
  v_permlane32_swap_b32 v57, v25
  v_permlane32_swap_b32 v58, v26
  v_permlane32_swap_b32 v59, v27
  v_mov_b32_dpp v56, v56 quad_perm:[0,0,2,2] row_mask:0xf bank_mask:0xf
  v_mov_b32_dpp v57, v57 quad_perm:[0,0,2,2] row_mask:0xf bank_mask:0xf
  v_mov_b32_dpp v58, v58 quad_perm:[0,0,2,2] row_mask:0xf bank_mask:0xf
  v_mov_b32_dpp v59, v59 quad_perm:[0,0,2,2] row_mask:0xf bank_mask:0xf
  v_add_f32_dpp v56, v24, v56 quad_perm:[1,1,3,3] row_mask:0xf bank_mask:0xf
  v_add_f32_dpp v57, v25, v57 quad_perm:[1,1,3,3] row_mask:0xf bank_mask:0xf
  v_add_f32_dpp v58, v26, v58 quad_perm:[1,1,3,3] row_mask:0xf bank_mask:0xf
  v_add_f32_dpp v59, v27, v59 quad_perm:[1,1,3,3] row_mask:0xf bank_mask:0xf
  v_cvt_pk_bf16_f32 v10, v56, v57
  v_cvt_pk_bf16_f32 v11, v58, v59
  v_lshlrev_b32 v56, 16, v10
  v_lshlrev_b32 v58, 16, v11
  v_and_b32 v57, s25, v10
  v_and_b32 v59, s25, v11
  v_mul_f32 v56, s24, v56
  v_mul_f32 v58, s24, v58
  v_mul_f32 v57, s24, v57
  v_mul_f32 v59, s24, v59
  v_cvt_pk_bf16_f32 v10, v56, v57
  v_cvt_pk_bf16_f32 v11, v58, v59
  v_lshlrev_b32 v56, 16, v10
  v_lshlrev_b32 v58, 16, v11
  v_and_b32 v57, s25, v10
  v_and_b32 v59, s25, v11
  v_max3_f32 v8, v8, v56, v57
  v_max3_f32 v8, v8, v58, v59
  s_waitcnt vmcnt(3)
  buffer_load_dwordx4 v[80:83], v5, s[40:43], s17 offen offset:0 nt
  v_permlane32_swap_b32 v60, v28
  v_permlane32_swap_b32 v61, v29
  v_permlane32_swap_b32 v62, v30
  v_permlane32_swap_b32 v63, v31
  v_mov_b32_dpp v60, v60 quad_perm:[0,0,2,2] row_mask:0xf bank_mask:0xf
  v_mov_b32_dpp v61, v61 quad_perm:[0,0,2,2] row_mask:0xf bank_mask:0xf
  v_mov_b32_dpp v62, v62 quad_perm:[0,0,2,2] row_mask:0xf bank_mask:0xf
  v_mov_b32_dpp v63, v63 quad_perm:[0,0,2,2] row_mask:0xf bank_mask:0xf
  v_add_f32_dpp v60, v28, v60 quad_perm:[1,1,3,3] row_mask:0xf bank_mask:0xf
  v_add_f32_dpp v61, v29, v61 quad_perm:[1,1,3,3] row_mask:0xf bank_mask:0xf
  v_add_f32_dpp v62, v30, v62 quad_perm:[1,1,3,3] row_mask:0xf bank_mask:0xf
  v_add_f32_dpp v63, v31, v63 quad_perm:[1,1,3,3] row_mask:0xf bank_mask:0xf
  v_cvt_pk_bf16_f32 v10, v60, v61
  v_cvt_pk_bf16_f32 v11, v62, v63
  v_lshlrev_b32 v60, 16, v10
  v_lshlrev_b32 v62, 16, v11
  v_and_b32 v61, s25, v10
  v_and_b32 v63, s25, v11
  v_mul_f32 v60, s24, v60
  v_mul_f32 v62, s24, v62
  v_mul_f32 v61, s24, v61
  v_mul_f32 v63, s24, v63
  v_cvt_pk_bf16_f32 v10, v60, v61
  v_cvt_pk_bf16_f32 v11, v62, v63
  v_lshlrev_b32 v60, 16, v10
  v_lshlrev_b32 v62, 16, v11
  v_and_b32 v61, s25, v10
  v_and_b32 v63, s25, v11
  v_max3_f32 v8, v8, v60, v61
  v_max3_f32 v8, v8, v62, v63
  s_waitcnt vmcnt(3)
  buffer_load_dwordx4 v[84:87], v5, s[40:43], s17 offen offset:1024 nt
  v_mov_b32 v9, v8
  s_nop 1
  v_permlane32_swap_b32 v8, v9
  v_max_f32 v8, v8, v9
  v_mov_b32 v9, v8
  s_nop 1
  v_permlane16_swap_b32 v8, v9
  v_max_f32 v8, v8, v9
  v_mul_f32 v8, s26, v8
  v_sub_f32 v10, 0, v8
  v_mov_b32 v9, 0
  v_mov_b32 v11, 0
  v_fma_f32 v32, v32, s26, v10
  v_fma_f32 v33, v33, s26, v10
  v_fma_f32 v34, v34, s26, v10
  v_fma_f32 v35, v35, s26, v10
  v_exp_f32 v32, v32
  v_exp_f32 v33, v33
  v_exp_f32 v34, v34
  v_exp_f32 v35, v35
  v_add_f32 v9, v9, v32
  v_cvt_pk_bf16_f32 v32, v32, v32
  v_and_b32 v192, v6, v32
  v_and_b32 v193, v7, v32
  v_add_f32 v11, v11, v33
  v_cvt_pk_bf16_f32 v33, v33, v33
  v_and_b32 v194, v6, v33
  v_and_b32 v195, v7, v33
  v_add_f32 v9, v9, v34
  v_cvt_pk_bf16_f32 v34, v34, v34
  v_and_b32 v196, v6, v34
  v_and_b32 v197, v7, v34
  v_add_f32 v11, v11, v35
  v_cvt_pk_bf16_f32 v35, v35, v35
  v_and_b32 v198, v6, v35
  v_and_b32 v199, v7, v35
  s_waitcnt vmcnt(3)
  buffer_load_dwordx4 v[88:91], v5, s[40:43], s17 offen offset:2048 nt
  v_fma_f32 v36, v36, s26, v10
  v_fma_f32 v37, v37, s26, v10
  v_fma_f32 v38, v38, s26, v10
  v_fma_f32 v39, v39, s26, v10
  v_exp_f32 v36, v36
  v_exp_f32 v37, v37
  v_exp_f32 v38, v38
  v_exp_f32 v39, v39
  v_add_f32 v9, v9, v36
  v_cvt_pk_bf16_f32 v36, v36, v36
  v_and_b32 v200, v6, v36
  v_and_b32 v201, v7, v36
  v_add_f32 v11, v11, v37
  v_cvt_pk_bf16_f32 v37, v37, v37
  v_and_b32 v202, v6, v37
  v_and_b32 v203, v7, v37
  v_add_f32 v9, v9, v38
  v_cvt_pk_bf16_f32 v38, v38, v38
  v_and_b32 v204, v6, v38
  v_and_b32 v205, v7, v38
  v_add_f32 v11, v11, v39
  v_cvt_pk_bf16_f32 v39, v39, v39
  v_and_b32 v206, v6, v39
  v_and_b32 v207, v7, v39
  v_fma_f32 v40, v40, s26, v10
  v_fma_f32 v41, v41, s26, v10
  v_fma_f32 v42, v42, s26, v10
  v_fma_f32 v43, v43, s26, v10
  v_exp_f32 v40, v40
  v_exp_f32 v41, v41
  v_exp_f32 v42, v42
  v_exp_f32 v43, v43
  v_add_f32 v9, v9, v40
  v_cvt_pk_bf16_f32 v40, v40, v40
  v_and_b32 v208, v6, v40
  v_and_b32 v209, v7, v40
  v_add_f32 v11, v11, v41
  v_cvt_pk_bf16_f32 v41, v41, v41
  v_and_b32 v210, v6, v41
  v_and_b32 v211, v7, v41
  v_add_f32 v9, v9, v42
  v_cvt_pk_bf16_f32 v42, v42, v42
  v_and_b32 v212, v6, v42
  v_and_b32 v213, v7, v42
  v_add_f32 v11, v11, v43
  v_cvt_pk_bf16_f32 v43, v43, v43
  v_and_b32 v214, v6, v43
  v_and_b32 v215, v7, v43
  s_waitcnt vmcnt(3)
  buffer_load_dwordx4 v[92:95], v5, s[40:43], s17 offen offset:3072 nt
  v_fma_f32 v44, v44, s26, v10
  v_fma_f32 v45, v45, s26, v10
  v_fma_f32 v46, v46, s26, v10
  v_fma_f32 v47, v47, s26, v10
  v_exp_f32 v44, v44
  v_exp_f32 v45, v45
  v_exp_f32 v46, v46
  v_exp_f32 v47, v47
  v_add_f32 v9, v9, v44
  v_cvt_pk_bf16_f32 v44, v44, v44
  v_and_b32 v216, v6, v44
  v_and_b32 v217, v7, v44
  v_add_f32 v11, v11, v45
  v_cvt_pk_bf16_f32 v45, v45, v45
  v_and_b32 v218, v6, v45
  v_and_b32 v219, v7, v45
  v_add_f32 v9, v9, v46
  v_cvt_pk_bf16_f32 v46, v46, v46
  v_and_b32 v220, v6, v46
  v_and_b32 v221, v7, v46
  v_add_f32 v11, v11, v47
  v_cvt_pk_bf16_f32 v47, v47, v47
  v_and_b32 v222, v6, v47
  v_and_b32 v223, v7, v47
  v_fma_f32 v48, v48, s26, v10
  v_fma_f32 v49, v49, s26, v10
  v_fma_f32 v50, v50, s26, v10
  v_fma_f32 v51, v51, s26, v10
  v_exp_f32 v48, v48
  v_exp_f32 v49, v49
  v_exp_f32 v50, v50
  v_exp_f32 v51, v51
  v_add_f32 v9, v9, v48
  v_cvt_pk_bf16_f32 v48, v48, v48
  v_and_b32 v224, v6, v48
  v_and_b32 v225, v7, v48
  v_add_f32 v11, v11, v49
  v_cvt_pk_bf16_f32 v49, v49, v49
  v_and_b32 v226, v6, v49
  v_and_b32 v227, v7, v49
  v_add_f32 v9, v9, v50
  v_cvt_pk_bf16_f32 v50, v50, v50
  v_and_b32 v228, v6, v50
  v_and_b32 v229, v7, v50
  v_add_f32 v11, v11, v51
  v_cvt_pk_bf16_f32 v51, v51, v51
  v_and_b32 v230, v6, v51
  v_and_b32 v231, v7, v51
  s_waitcnt vmcnt(3)
  buffer_load_dwordx4 v[96:99], v5, s[40:43], s18 offen offset:0 nt
  v_fma_f32 v52, v52, s26, v10
  v_fma_f32 v53, v53, s26, v10
  v_fma_f32 v54, v54, s26, v10
  v_fma_f32 v55, v55, s26, v10
  v_exp_f32 v52, v52
  v_exp_f32 v53, v53
  v_exp_f32 v54, v54
  v_exp_f32 v55, v55
  v_add_f32 v9, v9, v52
  v_cvt_pk_bf16_f32 v52, v52, v52
  v_and_b32 v232, v6, v52
  v_and_b32 v233, v7, v52
  v_add_f32 v11, v11, v53
  v_cvt_pk_bf16_f32 v53, v53, v53
  v_and_b32 v234, v6, v53
  v_and_b32 v235, v7, v53
  v_add_f32 v9, v9, v54
  v_cvt_pk_bf16_f32 v54, v54, v54
  v_and_b32 v236, v6, v54
  v_and_b32 v237, v7, v54
  v_add_f32 v11, v11, v55
  v_cvt_pk_bf16_f32 v55, v55, v55
  v_and_b32 v238, v6, v55
  v_and_b32 v239, v7, v55
  v_fma_f32 v56, v56, s26, v10
  v_fma_f32 v57, v57, s26, v10
  v_fma_f32 v58, v58, s26, v10
  v_fma_f32 v59, v59, s26, v10
  v_exp_f32 v56, v56
  v_exp_f32 v57, v57
  v_exp_f32 v58, v58
  v_exp_f32 v59, v59
  v_add_f32 v9, v9, v56
  v_cvt_pk_bf16_f32 v56, v56, v56
  v_and_b32 v240, v6, v56
  v_and_b32 v241, v7, v56
  v_add_f32 v11, v11, v57
  v_cvt_pk_bf16_f32 v57, v57, v57
  v_and_b32 v242, v6, v57
  v_and_b32 v243, v7, v57
  v_add_f32 v9, v9, v58
  v_cvt_pk_bf16_f32 v58, v58, v58
  v_and_b32 v244, v6, v58
  v_and_b32 v245, v7, v58
  v_add_f32 v11, v11, v59
  v_cvt_pk_bf16_f32 v59, v59, v59
  v_and_b32 v246, v6, v59
  v_and_b32 v247, v7, v59
  s_waitcnt vmcnt(3)
  buffer_load_dwordx4 v[100:103], v5, s[40:43], s18 offen offset:1024 nt
  v_fma_f32 v60, v60, s26, v10
  v_fma_f32 v61, v61, s26, v10
  v_fma_f32 v62, v62, s26, v10
  v_fma_f32 v63, v63, s26, v10
  v_exp_f32 v60, v60
  v_exp_f32 v61, v61
  v_exp_f32 v62, v62
  v_exp_f32 v63, v63
  v_add_f32 v9, v9, v60
  v_cvt_pk_bf16_f32 v60, v60, v60
  v_and_b32 v248, v6, v60
  v_and_b32 v249, v7, v60
  v_add_f32 v11, v11, v61
  v_cvt_pk_bf16_f32 v61, v61, v61
  v_and_b32 v250, v6, v61
  v_and_b32 v251, v7, v61
  v_add_f32 v9, v9, v62
  v_cvt_pk_bf16_f32 v62, v62, v62
  v_and_b32 v252, v6, v62
  v_and_b32 v253, v7, v62
  v_add_f32 v11, v11, v63
  v_cvt_pk_bf16_f32 v63, v63, v63
  v_and_b32 v254, v6, v63
  v_and_b32 v255, v7, v63
  v_add_f32 v9, v9, v11
  v_mov_b32 v11, v9
  s_nop 1
  v_permlane32_swap_b32 v9, v11
  v_add_f32 v9, v9, v11
  v_mov_b32 v11, v9
  s_nop 1
  v_permlane16_swap_b32 v9, v11
  v_add_f32 v9, v9, v11
  s_lshl_b32 s13, s3, 11
  v_lshlrev_b32 v29, 4, v1
  v_add_u32 v16, s13, v29
  s_lshl_b32 s13, s3, 3
  v_add_u32 v17, s13, v29
  s_mov_b32 exec_lo, 0x1111
  s_mov_b32 exec_hi, 0
  ds_write_b64 v17, v[8:9] offset:50432
  s_mov_b64 exec, -1
  s_waitcnt vmcnt(3)
  buffer_load_dwordx4 v[104:107], v5, s[40:43], s18 offen offset:2048 nt
  v_lshlrev_b32 v21, 8, v3
  s_lshl_b32 s13, s4, 12
  s_lshl_b32 s14, s6, 5
  s_add_u32 s13, s13, s14
  s_lshl_b32 s14, s7, 3
  s_add_u32 s13, s13, s14
  s_add_u32 s13, s13, 1572864
  v_add_u32 v21, s13, v21
  v_bfe_u32 v19, v1, 2, 2
  v_lshlrev_b32 v19, 6, v19
  s_cmp_lt_u32 s3, 4
  s_cbranch_scc1 L_prep03
  v_mul_u32_u24 v10, 4128, v2
  v_lshl_add_u32 v10, v3, 1, v10
  s_and_b32 s14, s3, 3
  s_lshl_b32 s13, s14, 5
  v_add_u32 v10, s13, v10
  ds_read_u16 v32, v10 offset:32768
  ds_read_u16 v33, v10 offset:33792
  ds_read_u16 v34, v10 offset:34816
  ds_read_u16 v35, v10 offset:35840
  ds_read_u16 v36, v10 offset:33280
  ds_read_u16 v37, v10 offset:34304
  ds_read_u16 v38, v10 offset:35328
  ds_read_u16 v39, v10 offset:36352
  ds_read_u16 v40, v10 offset:32896
  ds_read_u16 v41, v10 offset:33920
  ds_read_u16 v42, v10 offset:34944
  ds_read_u16 v43, v10 offset:35968
  ds_read_u16 v44, v10 offset:33408
  ds_read_u16 v45, v10 offset:34432
  ds_read_u16 v46, v10 offset:35456
  ds_read_u16 v47, v10 offset:36480
  ds_read_u16 v48, v10 offset:33024
  ds_read_u16 v49, v10 offset:34048
  ds_read_u16 v50, v10 offset:35072
  ds_read_u16 v51, v10 offset:36096
  ds_read_u16 v52, v10 offset:33536
  ds_read_u16 v53, v10 offset:34560
  ds_read_u16 v54, v10 offset:35584
  ds_read_u16 v55, v10 offset:36608
  ds_read_u16 v56, v10 offset:33152
  ds_read_u16 v57, v10 offset:34176
  ds_read_u16 v58, v10 offset:35200
  ds_read_u16 v59, v10 offset:36224
  ds_read_u16 v60, v10 offset:33664
  ds_read_u16 v61, v10 offset:34688
  ds_read_u16 v62, v10 offset:35712
  ds_read_u16 v63, v10 offset:36736
  s_lshl_b32 s13, s14, 12
  v_add_u32 v11, s13, v29
  s_and_b32 s11, s3, 1
  v_and_b32 v18, 1, v1
  v_lshlrev_b32 v18, 10, v18
  v_bfe_u32 v10, v1, 1, 2
  v_lshl_add_u32 v18, v10, 8, v18
  v_bfe_u32 v10, v1, 3, 2
  v_lshl_add_u32 v18, v10, 4, v18
  v_lshrrev_b32 v10, 5, v1
  s_lshl_b32 s13, s11, 1
  v_add_u32 v10, s13, v10
  v_lshl_add_u32 v18, v10, 6, v18
  v_lshrrev_b32 v10, 5, v1
  v_lshlrev_b32 v20, 14, v10
  v_bfe_u32 v10, v1, 3, 2
  v_lshl_add_u32 v20, v10, 10, v20
  v_and_b32 v10, 7, v1
  v_lshl_add_u32 v20, v10, 4, v20
  s_lshl_b32 s13, s4, 16
  s_lshl_b32 s14, s7, 12
  s_add_u32 s13, s13, s14
  s_lshl_b32 s14, s6, 7
  s_add_u32 s13, s13, s14
  s_add_u32 s13, s13, 1048576
  s_lshl_b32 s14, s11, 15
  s_add_u32 s13, s13, s14
  v_add_u32 v20, s13, v20
  s_lshl_b32 s13, s2, 12
  s_add_u32 s13, s13, 2097152
  v_lshlrev_b32 v27, 4, v1
  v_add_u32 v27, s13, v27
  s_lshl_b32 s13, s2, 5
  v_lshlrev_b32 v28, 3, v1
  v_add_u32 v28, s13, v28
  s_waitcnt lgkmcnt(0)
  v_lshl_or_b32 v32, v33, 16, v32
  v_lshl_or_b32 v33, v35, 16, v34
  v_lshl_or_b32 v34, v37, 16, v36
  v_lshl_or_b32 v35, v39, 16, v38
  v_lshl_or_b32 v36, v41, 16, v40
  v_lshl_or_b32 v37, v43, 16, v42
  v_lshl_or_b32 v38, v45, 16, v44
  v_lshl_or_b32 v39, v47, 16, v46
  v_lshl_or_b32 v40, v49, 16, v48
  v_lshl_or_b32 v41, v51, 16, v50
  v_lshl_or_b32 v42, v53, 16, v52
  v_lshl_or_b32 v43, v55, 16, v54
  v_lshl_or_b32 v44, v57, 16, v56
  v_lshl_or_b32 v45, v59, 16, v58
  v_lshl_or_b32 v46, v61, 16, v60
  v_lshl_or_b32 v47, v63, 16, v62
  ds_write_b128 v11, v[32:35] offset:52736
  ds_write_b128 v11, v[36:39] offset:53760
  ds_write_b128 v11, v[40:43] offset:54784
  ds_write_b128 v11, v[44:47] offset:55808
  s_branch L_pv
L_prep03:
  v_and_b32 v10, 7, v1
  v_lshlrev_b32 v22, 7, v10
  v_lshl_add_u32 v22, v2, 5, v22
  v_bfe_u32 v11, v1, 3, 1
  v_lshl_add_u32 v22, v11, 4, v22
  s_lshl_b32 s13, s10, 14
  s_lshl_b32 s14, s3, 10
  s_add_u32 s13, s13, s14
  s_add_u32 s13, s13, 1048576
  v_add_u32 v22, s13, v22
  s_lshl_b32 s13, s10, 10
  s_lshl_b32 s14, s3, 8
  s_add_u32 s13, s13, s14
  s_add_u32 s13, s13, 1572864
  v_lshlrev_b32 v23, 5, v10
  v_add_u32 v23, s13, v23
  v_lshlrev_b32 v25, 3, v1
  s_lshl_b32 s13, s3, 9
  v_add_u32 v24, s13, v25
  v_lshlrev_b32 v26, 17, v10
  v_lshl_add_u32 v26, v2, 4, v26
  s_lshl_b32 s13, s9, 2
  s_add_u32 s13, s13, s3
  s_lshl_b32 s13, s13, 12
  s_lshl_b32 s14, s10, 6
  s_add_u32 s13, s13, s14
  s_add_u32 s13, s13, 2097152
  v_add_u32 v26, s13, v26
  s_lshl_b32 s13, s3, 12
  v_add_u32 v30, s13, v29
L_pv:
  s_waitcnt vmcnt(10)
  v_mfma_f32_16x16x16_bf16 v[48:51], v[64:65], v[192:193], 0
  v_mfma_f32_16x16x16_bf16 v[52:55], v[66:67], v[192:193], 0
  s_waitcnt vmcnt(9)
  v_mfma_f32_16x16x16_bf16 v[48:51], v[68:69], v[194:195], v[48:51]
  v_mfma_f32_16x16x16_bf16 v[52:55], v[70:71], v[194:195], v[52:55]
  s_waitcnt vmcnt(8)
  v_mfma_f32_16x16x16_bf16 v[48:51], v[72:73], v[196:197], v[48:51]
  v_mfma_f32_16x16x16_bf16 v[52:55], v[74:75], v[196:197], v[52:55]
  s_waitcnt vmcnt(3)
  buffer_load_dwordx4 v[108:111], v5, s[40:43], s18 offen offset:3072 nt
  s_waitcnt vmcnt(8)
  v_mfma_f32_16x16x16_bf16 v[48:51], v[76:77], v[198:199], v[48:51]
  v_mfma_f32_16x16x16_bf16 v[52:55], v[78:79], v[198:199], v[52:55]
  s_waitcnt vmcnt(7)
  v_mfma_f32_16x16x16_bf16 v[48:51], v[80:81], v[200:201], v[48:51]
  v_mfma_f32_16x16x16_bf16 v[52:55], v[82:83], v[200:201], v[52:55]
  s_waitcnt vmcnt(6)
  v_mfma_f32_16x16x16_bf16 v[48:51], v[84:85], v[202:203], v[48:51]
  v_mfma_f32_16x16x16_bf16 v[52:55], v[86:87], v[202:203], v[52:55]
  s_waitcnt vmcnt(3)
  buffer_load_dwordx4 v[112:115], v5, s[40:43], s19 offen offset:0 nt
  s_waitcnt vmcnt(6)
  v_mfma_f32_16x16x16_bf16 v[48:51], v[88:89], v[204:205], v[48:51]
  v_mfma_f32_16x16x16_bf16 v[52:55], v[90:91], v[204:205], v[52:55]
  s_waitcnt vmcnt(5)
  v_mfma_f32_16x16x16_bf16 v[48:51], v[92:93], v[206:207], v[48:51]
  v_mfma_f32_16x16x16_bf16 v[52:55], v[94:95], v[206:207], v[52:55]
  s_waitcnt vmcnt(4)
  v_mfma_f32_16x16x16_bf16 v[48:51], v[96:97], v[208:209], v[48:51]
  v_mfma_f32_16x16x16_bf16 v[52:55], v[98:99], v[208:209], v[52:55]
  s_waitcnt vmcnt(3)
  buffer_load_dwordx4 v[116:119], v5, s[40:43], s19 offen offset:1024 nt
  s_waitcnt vmcnt(4)
  v_mfma_f32_16x16x16_bf16 v[48:51], v[100:101], v[210:211], v[48:51]
  v_mfma_f32_16x16x16_bf16 v[52:55], v[102:103], v[210:211], v[52:55]
  s_waitcnt vmcnt(3)
  buffer_load_dwordx4 v[120:123], v5, s[40:43], s19 offen offset:2048 nt
  s_waitcnt vmcnt(4)
  v_mfma_f32_16x16x16_bf16 v[48:51], v[104:105], v[212:213], v[48:51]
  v_mfma_f32_16x16x16_bf16 v[52:55], v[106:107], v[212:213], v[52:55]
  s_waitcnt vmcnt(3)
  buffer_load_dwordx4 v[124:127], v5, s[40:43], s19 offen offset:3072 nt
  s_waitcnt vmcnt(4)
  v_mfma_f32_16x16x16_bf16 v[48:51], v[108:109], v[214:215], v[48:51]
  v_mfma_f32_16x16x16_bf16 v[52:55], v[110:111], v[214:215], v[52:55]
  s_waitcnt vmcnt(3)
  buffer_load_dwordx4 v[128:131], v5, s[40:43], s20 offen offset:0 nt
  s_waitcnt vmcnt(4)
  v_mfma_f32_16x16x16_bf16 v[48:51], v[112:113], v[216:217], v[48:51]
  v_mfma_f32_16x16x16_bf16 v[52:55], v[114:115], v[216:217], v[52:55]
  s_waitcnt vmcnt(3)
  buffer_load_dwordx4 v[132:135], v5, s[40:43], s20 offen offset:1024 nt
  s_waitcnt vmcnt(4)
  v_mfma_f32_16x16x16_bf16 v[48:51], v[116:117], v[218:219], v[48:51]
  v_mfma_f32_16x16x16_bf16 v[52:55], v[118:119], v[218:219], v[52:55]
  s_waitcnt vmcnt(3)
  buffer_load_dwordx4 v[136:139], v5, s[40:43], s20 offen offset:2048 nt
  s_waitcnt vmcnt(4)
  v_mfma_f32_16x16x16_bf16 v[48:51], v[120:121], v[220:221], v[48:51]
  v_mfma_f32_16x16x16_bf16 v[52:55], v[122:123], v[220:221], v[52:55]
  s_waitcnt vmcnt(3)
  buffer_load_dwordx4 v[140:143], v5, s[40:43], s20 offen offset:3072 nt
  s_waitcnt vmcnt(4)
  v_mfma_f32_16x16x16_bf16 v[48:51], v[124:125], v[222:223], v[48:51]
  v_mfma_f32_16x16x16_bf16 v[52:55], v[126:127], v[222:223], v[52:55]
  s_waitcnt vmcnt(3)
  buffer_load_dwordx4 v[144:147], v5, s[40:43], s21 offen offset:0 nt
  s_waitcnt vmcnt(4)
  v_mfma_f32_16x16x16_bf16 v[48:51], v[128:129], v[224:225], v[48:51]
  v_mfma_f32_16x16x16_bf16 v[52:55], v[130:131], v[224:225], v[52:55]
  s_waitcnt vmcnt(3)
  buffer_load_dwordx4 v[148:151], v5, s[40:43], s21 offen offset:1024 nt
  s_waitcnt vmcnt(4)
  v_mfma_f32_16x16x16_bf16 v[48:51], v[132:133], v[226:227], v[48:51]
  v_mfma_f32_16x16x16_bf16 v[52:55], v[134:135], v[226:227], v[52:55]
  s_waitcnt vmcnt(3)
  buffer_load_dwordx4 v[152:155], v5, s[40:43], s21 offen offset:2048 nt
  s_waitcnt lgkmcnt(0)
  s_barrier
  ds_read_b128 v[32:35], v19 offset:50432
  ds_read_b128 v[36:39], v19 offset:50448
  ds_read_b128 v[40:43], v19 offset:50464
  ds_read_b128 v[44:47], v19 offset:50480
  s_waitcnt lgkmcnt(0)
  v_max3_f32 v58, v32, v34, v36
  v_max3_f32 v59, v38, v40, v42
  v_max3_f32 v58, v58, v44, v46
  v_max_f32 v58, v58, v59
  v_sub_f32 v57, v8, v58
  v_sub_f32 v32, v32, v58
  v_sub_f32 v34, v34, v58
  v_sub_f32 v36, v36, v58
  v_sub_f32 v38, v38, v58
  v_sub_f32 v40, v40, v58
  v_sub_f32 v42, v42, v58
  v_sub_f32 v44, v44, v58
  v_sub_f32 v46, v46, v58
  v_exp_f32 v57, v57
  v_exp_f32 v32, v32
  v_exp_f32 v34, v34
  v_exp_f32 v36, v36
  v_exp_f32 v38, v38
  v_exp_f32 v40, v40
  v_exp_f32 v42, v42
  v_exp_f32 v44, v44
  v_exp_f32 v46, v46
  v_mul_f32 v59, v32, v33
  v_fmac_f32 v59, v34, v35
  v_fmac_f32 v59, v36, v37
  v_fmac_f32 v59, v38, v39
  v_fmac_f32 v59, v40, v41
  v_fmac_f32 v59, v42, v43
  v_fmac_f32 v59, v44, v45
  v_fmac_f32 v59, v46, v47
  v_min_u32 v58, -2, v58
  v_min_u32 v59, -2, v59
  s_cmp_eq_u32 s3, 0
  s_cselect_b32 exec_lo, 0xffff, 0
  s_cselect_b32 exec_hi, 0, 0
  buffer_store_dwordx2 v[58:59], v21, s[60:63], 0 offen
  s_mov_b64 exec, -1
  v_mov_b32 v60, -1
  v_mov_b32 v61, -1
  v_mov_b32 v62, -1
  v_mov_b32 v63, -1
  s_lshr_b32 s13, s3, 1
  s_cmp_eq_u32 s13, 2
  s_cbranch_scc0 L_noreclr
  buffer_store_dwordx4 v[60:63], v20, s[60:63], 0 offen
L_noreclr:
  s_waitcnt vmcnt(4)
  v_mfma_f32_16x16x16_bf16 v[48:51], v[136:137], v[228:229], v[48:51]
  v_mfma_f32_16x16x16_bf16 v[52:55], v[138:139], v[228:229], v[52:55]
  s_waitcnt vmcnt(3)
  buffer_load_dwordx4 v[156:159], v5, s[40:43], s21 offen offset:3072 nt
  s_waitcnt vmcnt(4)
  v_mfma_f32_16x16x16_bf16 v[48:51], v[140:141], v[230:231], v[48:51]
  v_mfma_f32_16x16x16_bf16 v[52:55], v[142:143], v[230:231], v[52:55]
  s_waitcnt vmcnt(3)
  buffer_load_dwordx4 v[160:163], v5, s[40:43], s22 offen offset:0 nt
  s_waitcnt vmcnt(4)
  v_mfma_f32_16x16x16_bf16 v[48:51], v[144:145], v[232:233], v[48:51]
  v_mfma_f32_16x16x16_bf16 v[52:55], v[146:147], v[232:233], v[52:55]
  s_waitcnt vmcnt(3)
  buffer_load_dwordx4 v[164:167], v5, s[40:43], s22 offen offset:1024 nt
  s_waitcnt vmcnt(4)
  v_mfma_f32_16x16x16_bf16 v[48:51], v[148:149], v[234:235], v[48:51]
  v_mfma_f32_16x16x16_bf16 v[52:55], v[150:151], v[234:235], v[52:55]
  s_waitcnt vmcnt(3)
  buffer_load_dwordx4 v[168:171], v5, s[40:43], s22 offen offset:2048 nt
  s_waitcnt vmcnt(4)
  v_mfma_f32_16x16x16_bf16 v[48:51], v[152:153], v[236:237], v[48:51]
  v_mfma_f32_16x16x16_bf16 v[52:55], v[154:155], v[236:237], v[52:55]
  s_waitcnt vmcnt(3)
  buffer_load_dwordx4 v[172:175], v5, s[40:43], s22 offen offset:3072 nt
  s_waitcnt vmcnt(4)
  v_mfma_f32_16x16x16_bf16 v[48:51], v[156:157], v[238:239], v[48:51]
  v_mfma_f32_16x16x16_bf16 v[52:55], v[158:159], v[238:239], v[52:55]
  s_waitcnt vmcnt(3)
  buffer_load_dwordx4 v[176:179], v5, s[40:43], s23 offen offset:0 nt
  s_waitcnt vmcnt(4)
  v_mfma_f32_16x16x16_bf16 v[48:51], v[160:161], v[240:241], v[48:51]
  v_mfma_f32_16x16x16_bf16 v[52:55], v[162:163], v[240:241], v[52:55]
  s_waitcnt vmcnt(3)
  buffer_load_dwordx4 v[180:183], v5, s[40:43], s23 offen offset:1024 nt
  s_waitcnt vmcnt(4)
  v_mfma_f32_16x16x16_bf16 v[48:51], v[164:165], v[242:243], v[48:51]
  v_mfma_f32_16x16x16_bf16 v[52:55], v[166:167], v[242:243], v[52:55]
  s_waitcnt vmcnt(3)
  buffer_load_dwordx4 v[184:187], v5, s[40:43], s23 offen offset:2048 nt
  s_waitcnt vmcnt(4)
  v_mfma_f32_16x16x16_bf16 v[48:51], v[168:169], v[244:245], v[48:51]
  v_mfma_f32_16x16x16_bf16 v[52:55], v[170:171], v[244:245], v[52:55]
  s_waitcnt vmcnt(3)
  buffer_load_dwordx4 v[188:191], v5, s[40:43], s23 offen offset:3072 nt
  s_waitcnt vmcnt(4)
  v_mfma_f32_16x16x16_bf16 v[48:51], v[172:173], v[246:247], v[48:51]
  v_mfma_f32_16x16x16_bf16 v[52:55], v[174:175], v[246:247], v[52:55]
  s_waitcnt vmcnt(3)
  v_mfma_f32_16x16x16_bf16 v[48:51], v[176:177], v[248:249], v[48:51]
  v_mfma_f32_16x16x16_bf16 v[52:55], v[178:179], v[248:249], v[52:55]
  s_waitcnt vmcnt(2)
  v_mfma_f32_16x16x16_bf16 v[48:51], v[180:181], v[250:251], v[48:51]
  v_mfma_f32_16x16x16_bf16 v[52:55], v[182:183], v[250:251], v[52:55]
  s_waitcnt vmcnt(1)
  v_mfma_f32_16x16x16_bf16 v[48:51], v[184:185], v[252:253], v[48:51]
  v_mfma_f32_16x16x16_bf16 v[52:55], v[186:187], v[252:253], v[52:55]
  s_waitcnt vmcnt(0)
  v_mfma_f32_16x16x16_bf16 v[48:51], v[188:189], v[254:255], v[48:51]
  v_mfma_f32_16x16x16_bf16 v[52:55], v[190:191], v[254:255], v[52:55]
  s_nop 6
  v_mul_f32 v48, v48, v57
  v_mul_f32 v49, v49, v57
  v_mul_f32 v50, v50, v57
  v_mul_f32 v51, v51, v57
  v_mul_f32 v52, v52, v57
  v_mul_f32 v53, v53, v57
  v_mul_f32 v54, v54, v57
  v_mul_f32 v55, v55, v57
  ds_write_b128 v16, v[48:51] offset:0
  ds_write_b128 v16, v[52:55] offset:1024
  s_waitcnt lgkmcnt(0)
  s_barrier
  s_cmp_lt_u32 s3, 4
  s_cbranch_scc1 L_stageC
  s_setprio 3
  ds_read_b128 v[64:67], v18 offset:0
  ds_read_b128 v[68:71], v18 offset:2048
  ds_read_b128 v[72:75], v18 offset:4096
  ds_read_b128 v[76:79], v18 offset:6144
  ds_read_b128 v[80:83], v18 offset:8192
  ds_read_b128 v[84:87], v18 offset:10240
  ds_read_b128 v[88:91], v18 offset:12288
  ds_read_b128 v[92:95], v18 offset:14336
  s_waitcnt lgkmcnt(6)
  v_add_f32 v64, v64, v68
  v_add_f32 v65, v65, v69
  v_add_f32 v66, v66, v70
  v_add_f32 v67, v67, v71
  s_waitcnt lgkmcnt(5)
  v_add_f32 v64, v64, v72
  v_add_f32 v65, v65, v73
  v_add_f32 v66, v66, v74
  v_add_f32 v67, v67, v75
  s_waitcnt lgkmcnt(4)
  v_add_f32 v64, v64, v76
  v_add_f32 v65, v65, v77
  v_add_f32 v66, v66, v78
  v_add_f32 v67, v67, v79
  s_waitcnt lgkmcnt(3)
  v_add_f32 v64, v64, v80
  v_add_f32 v65, v65, v81
  v_add_f32 v66, v66, v82
  v_add_f32 v67, v67, v83
  s_waitcnt lgkmcnt(2)
  v_add_f32 v64, v64, v84
  v_add_f32 v65, v65, v85
  v_add_f32 v66, v66, v86
  v_add_f32 v67, v67, v87
  s_waitcnt lgkmcnt(1)
  v_add_f32 v64, v64, v88
  v_add_f32 v65, v65, v89
  v_add_f32 v66, v66, v90
  v_add_f32 v67, v67, v91
  s_waitcnt lgkmcnt(0)
  v_add_f32 v64, v64, v92
  v_add_f32 v65, v65, v93
  v_add_f32 v66, v66, v94
  v_add_f32 v67, v67, v95
  v_min_u32 v64, -2, v64
  v_min_u32 v65, -2, v65
  v_min_u32 v66, -2, v66
  v_min_u32 v67, -2, v67
  s_cmp_ge_u32 s3, 6
  s_cbranch_scc1 L_stageAB
  buffer_store_dwordx4 v[64:67], v20, s[60:63], 0 offen
  s_cmp_lg_u32 s3, 4
  s_cbranch_scc1 L_end
  s_barrier
  buffer_load_dwordx4 v[72:75], v27, s[60:63], 0 offen offset:0 sc1
  buffer_load_dwordx4 v[80:83], v27, s[60:63], 0 offen offset:2048 sc1
  buffer_load_dwordx4 v[76:79], v27, s[60:63], 0 offen offset:1024 sc1
  buffer_load_dwordx4 v[84:87], v27, s[60:63], 0 offen offset:3072 sc1
  s_mov_b64 s[0:1], -1
  s_mov_b64 s[24:25], -1
  s_mov_b32 s73, 200000
L_poll2:
  s_waitcnt vmcnt(0)
  s_mov_b64 exec, s[0:1]
  v_xor_b32 v8, s74, v74
  v_xor_b32 v9, s75, v75
  v_or_b32 v8, v8, v9
  v_xor_b32 v9, s74, v82
  v_or_b32 v8, v8, v9
  v_xor_b32 v9, s75, v83
  v_or_b32 v8, v8, v9
  v_cmp_ne_u32 s[0:1], 0, v8
  s_mov_b64 exec, s[24:25]
  v_xor_b32 v10, s74, v78
  v_xor_b32 v11, s75, v79
  v_or_b32 v10, v10, v11
  v_xor_b32 v11, s74, v86
  v_or_b32 v10, v10, v11
  v_xor_b32 v11, s75, v87
  v_or_b32 v10, v10, v11
  v_cmp_ne_u32 s[24:25], 0, v10
  s_mov_b64 exec, -1
  s_or_b64 vcc, s[0:1], s[24:25]
  s_cbranch_scc0 L_poll2_done
  s_mov_b64 exec, s[0:1]
  buffer_load_dwordx4 v[72:75], v27, s[60:63], 0 offen offset:0 sc1
  buffer_load_dwordx4 v[80:83], v27, s[60:63], 0 offen offset:2048 sc1
  s_mov_b64 exec, s[24:25]
  buffer_load_dwordx4 v[76:79], v27, s[60:63], 0 offen offset:1024 sc1
  buffer_load_dwordx4 v[84:87], v27, s[60:63], 0 offen offset:3072 sc1
  s_mov_b64 exec, -1
  s_sub_u32 s73, s73, 1
  s_cmp_lg_u32 s73, 0
  s_cbranch_scc1 L_poll2
  s_waitcnt vmcnt(0)
L_poll2_done:
  v_add_f32 v64, v72, v76
  v_add_f32 v65, v73, v77
  v_add_f32 v66, v80, v84
  v_add_f32 v67, v81, v85
  v_add_f32_dpp v68, v64, v64 row_ror:8 row_mask:0xf bank_mask:0xf
  v_add_f32_dpp v69, v65, v65 row_ror:8 row_mask:0xf bank_mask:0xf
  v_add_f32_dpp v70, v66, v66 row_ror:8 row_mask:0xf bank_mask:0xf
  v_add_f32_dpp v71, v67, v67 row_ror:8 row_mask:0xf bank_mask:0xf
  v_add_f32_dpp v64, v68, v68 row_ror:4 row_mask:0xf bank_mask:0xf
  v_add_f32_dpp v65, v69, v69 row_ror:4 row_mask:0xf bank_mask:0xf
  v_add_f32_dpp v66, v70, v70 row_ror:4 row_mask:0xf bank_mask:0xf
  v_add_f32_dpp v67, v71, v71 row_ror:4 row_mask:0xf bank_mask:0xf
  v_mov_b32 v68, v64
  v_mov_b32 v69, v65
  v_mov_b32 v70, v66
  v_mov_b32 v71, v67
  v_permlane16_swap_b32 v64, v68
  v_permlane16_swap_b32 v65, v69
  v_permlane16_swap_b32 v66, v70
  v_permlane16_swap_b32 v67, v71
  v_add_f32 v64, v64, v68
  v_add_f32 v65, v65, v69
  v_add_f32 v66, v66, v70
  v_add_f32 v67, v67, v71
  v_mov_b32 v68, v64
  v_mov_b32 v69, v65
  v_mov_b32 v70, v66
  v_mov_b32 v71, v67
  v_permlane32_swap_b32 v64, v68
  v_permlane32_swap_b32 v65, v69
  v_permlane32_swap_b32 v66, v70
  v_permlane32_swap_b32 v67, v71
  v_add_f32 v64, v64, v68
  v_add_f32 v65, v65, v69
  v_add_f32 v66, v66, v70
  v_add_f32 v67, v67, v71
  v_cvt_pk_bf16_f32 v60, v64, v65
  v_cvt_pk_bf16_f32 v61, v66, v67
  v_mov_b32 v62, s74
  v_mov_b32 v63, s75
  v_mov_b32 v8, 3149824
  s_mov_b32 exec_lo, 0xf
  s_mov_b32 exec_hi, 0
  buffer_store_dwordx2 v[60:61], v28, s[52:55], 0 offen
  s_cmp_eq_u32 s2, 0
  s_cselect_b32 exec_lo, 1, 0
  buffer_store_dwordx2 v[62:63], v8, s[60:63], 0 offen
  s_branch L_end
L_stageAB:
  buffer_store_dwordx4 v[64:67], v20, s[60:63], s12 offen sc1
  s_cmp_eq_u32 s3, 6
  s_cselect_b32 exec_lo, 0xffff, 0
  s_cselect_b32 exec_hi, 0, 0
  buffer_store_dwordx2 v[58:59], v21, s[60:63], s12 offen sc1
  s_branch L_end
L_stageC:
  buffer_load_dwordx4 v[80:83], v23, s[60:63], 0 offen sc1
  buffer_load_dwordx4 v[84:87], v23, s[60:63], 0 offen offset:16 sc1
  buffer_load_dwordx4 v[64:67], v22, s[60:63], 0 offen sc1
  buffer_load_dwordx4 v[68:71], v22, s[60:63], s65 offen sc1
  buffer_load_dwordx4 v[72:75], v22, s[60:63], s66 offen sc1
  buffer_load_dwordx4 v[76:79], v22, s[60:63], s67 offen sc1
  ds_read_b128 v[32:35], v30 offset:52736
  ds_read_b128 v[36:39], v30 offset:53760
  ds_read_b128 v[40:43], v30 offset:54784
  ds_read_b128 v[44:47], v30 offset:55808
  v_mov_b32 v98, s74
  v_mov_b32 v99, s75
  v_mov_b32 v102, s74
  v_mov_b32 v103, s75
  s_mov_b64 s[0:1], -1
  s_waitcnt vmcnt(4)
  s_mov_b64 exec, s[0:1]
  v_max3_u32 v12, v80, v81, v82
  v_max3_u32 v12, v12, v83, v84
  v_max3_u32 v12, v12, v85, v86
  v_max_u32 v12, v12, v87
  v_cmp_eq_u32 s[0:1], -1, v12
  s_mov_b64 exec, -1
  s_or_b64 vcc, s[0:1], s[0:1]
  s_cbranch_scc0 L_pollm_done
  s_mov_b64 s[0:1], -1
  s_mov_b32 s73, 200000
L_pollm:
  s_mov_b64 exec, s[0:1]
  s_cbranch_execz L_pollm_s0
  buffer_load_dwordx4 v[80:83], v23, s[60:63], 0 offen sc1
  buffer_load_dwordx4 v[84:87], v23, s[60:63], 0 offen offset:16 sc1
L_pollm_s0:
  s_waitcnt vmcnt(0)
  s_mov_b64 exec, s[0:1]
  v_max3_u32 v12, v80, v81, v82
  v_max3_u32 v12, v12, v83, v84
  v_max3_u32 v12, v12, v85, v86
  v_max_u32 v12, v12, v87
  v_cmp_eq_u32 s[0:1], -1, v12
  s_mov_b64 exec, -1
  s_or_b64 vcc, s[0:1], s[0:1]
  s_cbranch_scc0 L_pollm_done
  s_sleep 2
  s_cmp_le_u32 s73, 199984
  s_cselect_b32 s13, 4194304, 0
  v_xor_b32 v23, s13, v23
  s_sub_u32 s73, s73, 1
  s_cmp_lg_u32 s73, 0
  s_cbranch_scc1 L_pollm
L_pollm_done:
  v_max3_f32 v8, v80, v82, v84
  v_max_f32 v8, v8, v86
  v_sub_f32 v88, v80, v8
  v_sub_f32 v89, v82, v8
  v_sub_f32 v90, v84, v8
  v_sub_f32 v91, v86, v8
  v_exp_f32 v88, v88
  v_exp_f32 v89, v89
  v_exp_f32 v90, v90
  v_exp_f32 v91, v91
  v_mul_f32 v9, v88, v81
  v_fmac_f32 v9, v89, v83
  v_fmac_f32 v9, v90, v85
  v_fmac_f32 v9, v91, v87
  v_rcp_f32 v9, v9
  s_nop 0
  v_mul_f32 v88, v88, v9
  v_mul_f32 v89, v89, v9
  v_mul_f32 v90, v90, v9
  v_mul_f32 v91, v91, v9
  s_mov_b64 s[0:1], -1
  s_mov_b64 s[24:25], -1
  s_mov_b64 s[26:27], -1
  s_mov_b64 s[28:29], -1
  s_mov_b32 s73, 32
L_poll1p:
  s_waitcnt vmcnt(0)
  s_mov_b64 exec, s[0:1]
  v_max3_u32 v10, v64, v65, v66
  v_max_u32 v10, v10, v67
  v_cmp_eq_u32 s[0:1], -1, v10
  s_mov_b64 exec, s[24:25]
  v_max3_u32 v12, v68, v69, v70
  v_max_u32 v12, v12, v71
  v_cmp_eq_u32 s[24:25], -1, v12
  s_mov_b64 exec, s[26:27]
  v_max3_u32 v10, v72, v73, v74
  v_max_u32 v10, v10, v75
  v_cmp_eq_u32 s[26:27], -1, v10
  s_mov_b64 exec, s[28:29]
  v_max3_u32 v12, v76, v77, v78
  v_max_u32 v12, v12, v79
  v_cmp_eq_u32 s[28:29], -1, v12
  s_mov_b64 exec, -1
  s_or_b64 vcc, s[0:1], s[24:25]
  s_or_b64 vcc, vcc, s[26:27]
  s_or_b64 vcc, vcc, s[28:29]
  s_cbranch_scc0 L_poll1_done
  s_sleep 1
  s_mov_b64 exec, s[0:1]
  buffer_load_dwordx4 v[64:67], v22, s[60:63], 0 offen sc1
  s_mov_b64 exec, s[24:25]
  buffer_load_dwordx4 v[68:71], v22, s[60:63], s65 offen sc1
  s_mov_b64 exec, s[26:27]
  buffer_load_dwordx4 v[72:75], v22, s[60:63], s66 offen sc1
  s_mov_b64 exec, s[28:29]
  buffer_load_dwordx4 v[76:79], v22, s[60:63], s67 offen sc1
  s_mov_b64 exec, -1
  s_sub_u32 s73, s73, 1
  s_cmp_lg_u32 s73, 0
  s_cbranch_scc1 L_poll1p
  s_waitcnt vmcnt(0)
  s_mov_b64 s[0:1], -1
  s_mov_b64 s[24:25], -1
  s_mov_b64 s[26:27], -1
  s_mov_b64 s[28:29], -1
  s_mov_b32 s73, 200000
L_poll1:
  s_mov_b64 exec, s[0:1]
  s_cbranch_execz L_poll1_s0
  buffer_load_dwordx4 v[64:67], v22, s[60:63], 0 offen sc1
L_poll1_s0:
  s_mov_b64 exec, s[24:25]
  s_cbranch_execz L_poll1_s1
  buffer_load_dwordx4 v[68:71], v22, s[60:63], s65 offen sc1
L_poll1_s1:
  s_mov_b64 exec, s[26:27]
  s_cbranch_execz L_poll1_s2
  buffer_load_dwordx4 v[72:75], v22, s[60:63], s66 offen sc1
L_poll1_s2:
  s_mov_b64 exec, s[28:29]
  s_cbranch_execz L_poll1_s3
  buffer_load_dwordx4 v[76:79], v22, s[60:63], s67 offen sc1
L_poll1_s3:
  s_waitcnt vmcnt(0)
  s_mov_b64 exec, s[0:1]
  v_max3_u32 v12, v64, v65, v66
  v_max_u32 v12, v12, v67
  v_cmp_eq_u32 s[0:1], -1, v12
  s_mov_b64 exec, s[24:25]
  v_max3_u32 v13, v68, v69, v70
  v_max_u32 v13, v13, v71
  v_cmp_eq_u32 s[24:25], -1, v13
  s_mov_b64 exec, s[26:27]
  v_max3_u32 v10, v72, v73, v74
  v_max_u32 v10, v10, v75
  v_cmp_eq_u32 s[26:27], -1, v10
  s_mov_b64 exec, s[28:29]
  v_max3_u32 v11, v76, v77, v78
  v_max_u32 v11, v11, v79
  v_cmp_eq_u32 s[28:29], -1, v11
  s_mov_b64 exec, -1
  s_or_b64 vcc, s[0:1], s[24:25]
  s_or_b64 vcc, vcc, s[26:27]
  s_or_b64 vcc, vcc, s[28:29]
  s_cbranch_scc0 L_poll1_done
  s_sleep 2
  s_cmp_le_u32 s73, 200000
  s_cselect_b32 s13, 4194304, 0
  v_xor_b32 v22, s13, v22
  s_sub_u32 s73, s73, 1
  s_cmp_lg_u32 s73, 0
  s_cbranch_scc1 L_poll1
L_poll1_done:
  v_mul_f32 v56, v88, v64
  v_mul_f32 v57, v88, v65
  v_mul_f32 v58, v88, v66
  v_mul_f32 v59, v88, v67
  v_fmac_f32 v56, v89, v68
  v_fmac_f32 v57, v89, v69
  v_fmac_f32 v58, v89, v70
  v_fmac_f32 v59, v89, v71
  v_fmac_f32 v56, v90, v72
  v_fmac_f32 v57, v90, v73
  v_fmac_f32 v58, v90, v74
  v_fmac_f32 v59, v90, v75
  v_fmac_f32 v56, v91, v76
  v_fmac_f32 v57, v91, v77
  v_fmac_f32 v58, v91, v78
  v_fmac_f32 v59, v91, v79
  v_cvt_pk_bf16_f32 v60, v56, v57
  v_cvt_pk_bf16_f32 v61, v58, v59
  ds_write_b64 v24, v[60:61] offset:50688
  s_waitcnt lgkmcnt(0)
  s_barrier
  ds_read_b64 v[104:105], v25 offset:50688
  ds_read_b64 v[106:107], v25 offset:51200
  ds_read_b64 v[108:109], v25 offset:51712
  ds_read_b64 v[110:111], v25 offset:52224
  s_waitcnt lgkmcnt(3)
  v_mfma_f32_16x16x16_bf16 v[48:51], v[32:33], v[104:105], 0
  v_mfma_f32_16x16x16_bf16 v[52:55], v[34:35], v[104:105], 0
  s_waitcnt lgkmcnt(2)
  v_mfma_f32_16x16x16_bf16 v[48:51], v[36:37], v[106:107], v[48:51]
  v_mfma_f32_16x16x16_bf16 v[52:55], v[38:39], v[106:107], v[52:55]
  s_waitcnt lgkmcnt(1)
  v_mfma_f32_16x16x16_bf16 v[48:51], v[40:41], v[108:109], v[48:51]
  v_mfma_f32_16x16x16_bf16 v[52:55], v[42:43], v[108:109], v[52:55]
  s_waitcnt lgkmcnt(0)
  v_mfma_f32_16x16x16_bf16 v[48:51], v[44:45], v[110:111], v[48:51]
  v_mfma_f32_16x16x16_bf16 v[52:55], v[46:47], v[110:111], v[52:55]
  s_nop 7
  v_add_f32_dpp v96, v52, v48 row_shl:8 row_mask:0xf bank_mask:0xf bound_ctrl:0
  v_add_f32_dpp v97, v53, v49 row_shl:8 row_mask:0xf bank_mask:0xf bound_ctrl:0
  v_add_f32_dpp v100, v54, v50 row_shl:8 row_mask:0xf bank_mask:0xf bound_ctrl:0
  v_add_f32_dpp v101, v55, v51 row_shl:8 row_mask:0xf bank_mask:0xf bound_ctrl:0
  s_mov_b32 exec_lo, 0x00ff00ff
  s_mov_b32 exec_hi, 0x00ff00ff
  buffer_store_dwordx4 v[96:99], v26, s[60:63], 0 offen sc1
  buffer_store_dwordx4 v[100:103], v26, s[60:63], 0 offen offset:2048 sc1
L_end:
  s_endpgm
.section .rodata,"a"
.p2align 6
.amdhsa_kernel standalone__gqa_block_cached__decode_kernel
  .amdhsa_next_free_vgpr 256
  .amdhsa_next_free_sgpr 102
  .amdhsa_accum_offset 256
  .amdhsa_group_segment_fixed_size 0
  .amdhsa_kernarg_size 64
  .amdhsa_user_sgpr_count 2
  .amdhsa_user_sgpr_kernarg_segment_ptr 1
  .amdhsa_system_sgpr_workgroup_id_x 1
.end_amdhsa_kernel
```
